```python
import torch

def _softmax(x, axis=-1):
    return torch.softmax(x, dim=axis)
def _gelu(x):
    return torch.nn.functional.gelu(x, approximate="tanh")
def _silu(x):
    return torch.nn.functional.silu(x)
def _sigmoid(x):
    return torch.sigmoid(x)
def _layernorm(x, axis=-1, eps=1e-5):
    m = x.mean(dim=axis, keepdim=True)
    v = x.var(dim=axis, keepdim=True, unbiased=False)
    return (x - m) / torch.sqrt(v + eps)
def _scatter_add(tgt, idx, src, axis=0):
    return tgt.clone().index_add_(axis, idx, src)
def _segment_sum(src, seg, n):
    out = torch.zeros((n,) + src.shape[1:], dtype=src.dtype)
    return out.index_add_(0, seg, src)
def _pad(x, pw):
    flat = tuple(v for pair in reversed(pw) for v in pair)
    return torch.nn.functional.pad(x, flat)

kernel_name = 'parallel_sum__ssm_conv_h3__mixer_channel_mlp__prompt'

def setup_inputs():

    _w = (lambda a: (lambda t: t.to(torch.bfloat16) if t.is_floating_point() else t)(torch.as_tensor(a)))
    def _A_setup():
        B, S, D = 1, 2048, 512
        ks = 4
        return {
            "q": _w((lambda *s: torch.randn(*s, dtype=torch.bfloat16) * 0.05)(B, S, D)),
            "k": _w((lambda *s: torch.randn(*s, dtype=torch.bfloat16) * 0.2)(B, S, D)),
            "v": _w((lambda *s: torch.randn(*s, dtype=torch.bfloat16) * 0.2)(B, S, D)),
            "shift_k": _w((lambda *s: torch.randn(*s, dtype=torch.bfloat16) * 0.2)(D, ks) * 0.5),
            "ssm_k": _w((lambda *s: torch.randn(*s, dtype=torch.bfloat16) * 0.8)(D, S) * (1.0 / S ** 0.5)),
            "ssm_D": _w((lambda *s: torch.randn(*s, dtype=torch.bfloat16) * 0.2)(D)),
        }
    _A_in = _A_setup()

    def _B_setup():
        B, S, D, F = 1, 2048, 512, 1376
        return {
            "x": _w((lambda *s: torch.randn(*s, dtype=torch.bfloat16) * 0.05)(B, S, D)),
            "w1": _w((lambda *s: torch.randn(*s, dtype=torch.bfloat16) * 0.8)(D, F) * (D ** -0.5)),
            "b1": _w((lambda *s: torch.randn(*s, dtype=torch.bfloat16) * 0.4)(F)),
            "w2": _w((lambda *s: torch.randn(*s, dtype=torch.bfloat16) * 0.05)(F, D) * (F ** -0.5)),
            "b2": _w((lambda *s: torch.randn(*s, dtype=torch.bfloat16) * 0.05)(D)),
        }
    _B_in = _B_setup()

    return {
        "A_q": _A_in["q"],
        "A_k": _A_in["k"],
        "A_v": _A_in["v"],
        "A_shift_k": _A_in["shift_k"],
        "A_ssm_k": _A_in["ssm_k"],
        "A_ssm_D": _A_in["ssm_D"],
        "B_x": _B_in["x"],
        "B_w1": _B_in["w1"],
        "B_b1": _B_in["b1"],
        "B_w2": _B_in["w2"],
        "B_b2": _B_in["b2"],
    }

def reference(A_q, A_k, A_v, A_shift_k, A_ssm_k, A_ssm_D, B_x, B_w1, B_b1, B_w2, B_b2):
    def _A_ref(q, k, v, shift_k, ssm_k, ssm_D):
        B, S, D = q.shape
        ks = shift_k.shape[-1]
        k_pad = _pad(k, ((0, 0), (ks - 1, 0), (0, 0)))
        k_shift = torch.zeros_like(k)
        for t in range(ks):
            k_shift = k_shift + k_pad[:, t:t + S, :] * shift_k[:, ks - 1 - t][None, None, :]
        kv = k_shift * v
        L = 2 * S
        kv_pad = _pad(kv, ((0, 0), (0, S), (0, 0)))
        kf_pad = _pad(ssm_k, ((0, 0), (0, S)))
        kv_f = (lambda x, axes=(-2,-1): torch.fft.rfft2(x.float(), dim=axes))(kv_pad[:, None, :, :], axes=(1, 2))
        kf_f = (lambda x, axes=(-2,-1): torch.fft.rfft2(x.float(), dim=axes))(kf_pad[:, None, :], axes=(1, 2))
        kf_f = (lambda x, *d: x.permute(*d))(kf_f, 1, 2, 0)
        y_f = kv_f * kf_f[None, :, :, :]
        y = (lambda x, s, axes=(-2,-1): torch.fft.irfft2(x, s=s, dim=axes).to(torch.bfloat16))(y_f, (1, L), axes=(1, 2))[:, 0, :S, :]
        y = y + kv * ssm_D[None, None, :]
        return q * y

    def _B_ref(x, w1, b1, w2, b2):
        y = _layernorm(x, axis=-1)
        h = _gelu(torch.einsum("bsd,df->bsf", y, w1) + b1)
        return torch.einsum("bsf,fd->bsd", h, w2) + b2

    x = A_q
    xn = _layernorm(x, axis=-1)
    return x + _A_ref(xn, A_k, A_v, A_shift_k, A_ssm_k, A_ssm_D) + _B_ref(xn, B_w1, B_b1, B_w2, B_b2)
```

```asm
; @launch grid=(256,1,1) block=(512,1,1) lds=163840
.amdgcn_target "amdgcn-amd-amdhsa--gfx950"
.text
.globl parallel_sum__ssm_conv_h3__mixer_channel_mlp__prompt_kernel
.p2align 12
.p2align 8
.type parallel_sum__ssm_conv_h3__mixer_channel_mlp__prompt_kernel,@function
parallel_sum__ssm_conv_h3__mixer_channel_mlp__prompt_kernel:
    s_cmp_ge_u32 s2, 256
    s_cbranch_scc1 L_end
    s_load_dwordx16 s[4:19], s[0:1], 0
    s_load_dwordx8 s[20:27], s[0:1], 64
    s_load_dwordx4 s[28:31], s[0:1], 96
    v_lshrrev_b32 v1, 6, v0
    v_and_b32 v0, 63, v0
    v_readfirstlane_b32 s3, v1
    s_lshr_b32 s38, s2, 3
    s_and_b32 s33, s38, 3
    s_and_b32 s34, s2, 1
    s_lshl_b32 s34, s34, 2
    s_add_u32 s33, s33, s34
    s_lshr_b32 s39, s38, 2
    s_and_b32 s34, s2, 6
    s_lshl_b32 s34, s34, 2
    s_add_u32 s34, s34, s39
    s_and_b32 s36, s3, 3
    v_lshrrev_b32 v4, 3, v0
    v_and_b32 v5, 7, v0
    s_lshl_b32 s68, s38, 3
    s_add_u32 s68, s68, s3
    s_lshl_b32 s68, s68, 7
    s_min_u32 s68, s68, L_end-L_pc-64
    v_lshl_add_u32 v89, v0, 6, s68
    s_getpc_b64 s[68:69]
L_pc:
    s_mov_b64 exec, 3
    global_load_dword v91, v89, s[68:69]
    s_mov_b64 exec, -1
    s_add_u32 s65, s3, s33
    s_and_b32 s65, s65, 7
    v_mul_u32_u24 v144, 1152, v4
    s_lshl_b32 s68, s34, 3
    s_and_b32 s64, s65, 3
    s_add_u32 s68, s68, s64
    s_lshl_b32 s68, s68, 13
    s_and_b32 s64, s65, 4
    s_lshl_b32 s64, s64, 13
    v_lshl_add_u32 v144, v5, 4, v144
    v_add_u32 v144, s68, v144
    s_mov_b32 s62, 0x200000
    s_mov_b32 s63, 0x20000
    v_xor_b32 v208, 128, v144
    v_xor_b32 v209, 256, v144
    v_xor_b32 v210, 384, v144
    v_xor_b32 v211, 512, v144
    v_xor_b32 v212, 640, v144
    v_xor_b32 v213, 768, v144
    v_xor_b32 v214, 896, v144
    s_cmp_lt_u32 s3, 4
    s_cbranch_scc1 L_mlp
    s_and_b32 s68, s33, 3
    s_lshl_b32 s69, s34, 2
    s_add_u32 s68, s68, s69
    s_lshl_b32 s68, s68, 2
    s_add_u32 s68, s68, s36
    s_mul_i32 s68, s68, 43
    s_lshr_b32 s69, s33, 2
    s_mul_i32 s69, s69, 21
    s_add_u32 s68, s68, s69
    s_and_b32 s68, s68, -2
    v_add_lshl_u32 v88, s68, v0, 6
    v_lshrrev_b32 v2, 1, v0
    v_lshlrev_b32 v2, 10, v2
    v_and_b32 v3, 1, v0
    v_lshl_add_u32 v86, v3, 6, v2
    s_lshl_b32 s68, s34, 2
    s_and_b32 s69, s33, 3
    s_add_u32 s68, s68, s69
    s_lshl_b32 s68, s68, 2
    s_add_u32 s68, s68, s36
    s_lshl_b32 s68, s68, 12
    s_cmp_lt_u32 s33, 4
    s_cselect_b32 s66, 0xff, 1
    s_mov_b32 s67, 0
    v_add_u32 v86, s68, v86
    s_mov_b32 s58, 1409024
    s_mov_b32 s59, 0x20000
    s_setprio 3
    s_waitcnt lgkmcnt(0)
    s_mov_b64 s[56:57], s[18:19]
    s_mov_b64 s[60:61], s[4:5]
    v_mov_b32 v87, v88
    s_mov_b64 exec, s[66:67]
    global_load_dword v84, v86, s[6:7] offset:384
    global_load_dword v85, v86, s[8:9] offset:384
    s_mov_b64 exec, -1
    s_setprio 1
    s_branch L_helper
L_mlp:
    s_setprio 1
    s_waitcnt lgkmcnt(0)
    s_mov_b64 s[60:61], s[4:5]
    buffer_load_dwordx4 v[152:155], v144, s[60:63], s64 offen
    buffer_load_dwordx4 v[156:159], v208, s[60:63], s64 offen
    buffer_load_dwordx4 v[160:163], v209, s[60:63], s64 offen
    buffer_load_dwordx4 v[164:167], v210, s[60:63], s64 offen
    buffer_load_dwordx4 v[168:171], v211, s[60:63], s64 offen
    buffer_load_dwordx4 v[172:175], v212, s[60:63], s64 offen
    buffer_load_dwordx4 v[176:179], v213, s[60:63], s64 offen
    buffer_load_dwordx4 v[180:183], v214, s[60:63], s64 offen
    s_xor_b32 s48, s64, 0x8000
    s_lshl_b32 s69, s65, 7
    v_xor_b32 v145, v4, v5
    v_lshl_add_u32 v145, v145, 4, s69
    v_lshl_add_u32 v145, v0, 10, v145
    s_add_u32 s69, s69, 66560
    v_lshl_add_u32 v146, v4, 3, s69
    v_mov_b32 v147, 0x3f803f80
    v_mov_b32 v148, 0x3f80
    v_mov_b32 v149, 1.0
    v_xor_b32 v216, 8192, v145
    v_xor_b32 v217, 16384, v145
    v_xor_b32 v218, 24576, v145
    v_xor_b32 v219, 32768, v145
    v_xor_b32 v220, 40960, v145
    v_xor_b32 v221, 49152, v145
    v_xor_b32 v222, 57344, v145
    s_lshl_b32 s52, s34, 7
    s_add_u32 s52, s52, 10617856
    s_load_dword s28, s[30:31], s52
    s_lshr_b32 s66, s36, 1
    s_and_b32 s67, s36, 1
    v_and_b32 v9, 31, v0
    s_mul_i32 s35, s33, 43
    s_add_u32 s35, s35, 3
    s_lshr_b32 s35, s35, 3
    s_and_b32 s37, s35, 1
    s_add_u32 s68, s35, s67
    s_lshl_b32 s69, s68, 6
    v_lshl_add_u32 v85, v9, 1, s69
    s_add_u32 s68, s68, 4
    s_min_u32 s68, s68, 42
    s_lshl_b32 s69, s68, 6
    v_lshl_add_u32 v86, v9, 1, s69
    v_and_b32 v9, 15, v0
    v_lshrrev_b32 v10, 4, v0
    s_lshl_b32 s68, s66, 5
    v_add_u32 v87, s68, v9
    v_xor_b32 v11, v87, v10
    v_lshlrev_b32 v11, 4, v11
    v_lshl_add_u32 v11, v10, 10, v11
    v_xor_b32 v12, 64, v11
    v_lshrrev_b32 v15, 3, v87
    v_lshlrev_b32 v15, 7, v15
    v_lshl_add_u32 v15, v5, 3, v15
    v_add_u32 v15, 66560, v15
    v_lshrrev_b32 v88, 2, v9
    v_and_b32 v89, 1, v88
    v_cmp_eq_u32 vcc, s37, v89
    v_lshrrev_b32 v89, 1, v88
    v_and_b32 v13, 3, v0
    v_lshlrev_b32 v13, 3, v13
    v_lshl_add_u32 v13, v10, 9, v13
    v_and_b32 v14, 16, v0
    v_lshl_add_u32 v90, v14, 1, v13
    v_lshl_add_u32 v90, v89, 7, v90
    v_lshl_add_u32 v13, v88, 7, v13
    v_and_b32 v14, 3, v4
    v_lshl_add_u32 v13, v14, 5, v13
    s_lshl_b32 s68, s67, 12
    v_add_u32 v120, s68, v13
    v_xor_b32 v121, 32, v120
    v_xor_b32 v122, 64, v120
    v_xor_b32 v123, 96, v120
    s_lshl_b32 s69, s67, 6
    s_cmp_eq_u32 s67, 0
    s_mov_b32 s68, 131072
    s_cselect_b32 s68, 65600, s68
    v_mov_b32 v13, s68
    v_mov_b32 v14, 98304
    v_add_u32 v14, s69, v14
    v_cndmask_b32 v13, v13, v14, vcc
    v_add_u32 v116, v13, v90
    s_mov_b32 s68, 32768
    s_cselect_b32 s68, 131136, s68
    v_mov_b32 v13, s68
    v_mov_b32 v14, 0
    v_add_u32 v14, s69, v14
    v_cndmask_b32 v13, v13, v14, vcc
    v_add_u32 v117, v13, v90
    s_mov_b32 s68, 65536
    s_cselect_b32 s68, 32832, s68
    v_mov_b32 v13, s68
    v_mov_b32 v14, 98304
    v_add_u32 v14, s69, v14
    v_cndmask_b32 v13, v13, v14, vcc
    v_add_u32 v118, v13, v90
    s_lshl_b32 s68, s66, 5
    s_add_u32 s68, s68, s69
    v_add_u32 v107, s68, v9
    v_mul_u32_u24 v107, 272, v107
    v_lshl_add_u32 v107, v10, 4, v107
    v_add_u32 v107, 98304, v107
    v_and_b32 v6, 6, v4
    v_xor_b32 v6, v5, v6
    v_lshlrev_b32 v6, 4, v6
    v_lshl_add_u32 v6, v4, 10, v6
    s_lshl_b32 s68, s36, 13
    s_lshl_b32 s69, s33, 7
    s_add_u32 s68, s68, s69
    v_add_u32 v126, s68, v6
    v_mov_b32 v127, 159744
    v_mov_b32 v1, 1
    s_mov_b32 s40, s30
    s_mov_b32 s41, s31
    s_mov_b32 s42, 0xa22000
    s_mov_b32 s43, 0x20000
    s_mov_b32 s44, s22
    s_mov_b32 s45, s23
    s_mov_b32 s46, 0x158000
    s_mov_b32 s47, 0x20000
    s_lshl_b32 s68, s34, 1
    s_add_u32 s68, s68, s66
    s_mul_i32 s68, s68, 90112
    s_add_u32 s68, s68, 4325376
    v_lshl_add_u32 v2, v0, 4, s68
    s_lshl_b32 s68, s67, 11
    v_add_u32 v3, s68, v2
    s_lshl_b32 s68, s34, 9
    s_lshl_b32 s69, s66, 7
    s_add_u32 s68, s68, s69
    s_add_u32 s70, s68, 10092544
    s_lshl_b32 s69, s33, 1
    s_add_u32 s69, s69, s67
    s_lshl_b32 s54, s69, 2
    s_add_u32 s26, s70, s54
    s_lshl_b32 s54, s69, 11
    s_add_u32 s55, s54, 32768
    s_lshl_b32 s68, s33, 2
    s_sub_u32 s25, s35, s68
    s_sub_i32 s24, s25, s67
    s_add_u32 s68, s25, s67
    s_add_u32 s68, s68, 32
    s_lshl_b32 s56, s68, 11
    s_mul_i32 s68, s33, 43
    s_add_u32 s68, s68, 46
    s_lshr_b32 s68, s68, 3
    s_sub_u32 s68, s68, s35
    s_sub_u32 s68, s68, s67
    s_cmp_eq_u32 s68, 4
    s_cselect_b32 s56, 0x7f000000, s56
    s_mov_b64 s[58:59], 0xffff
    s_mov_b32 s64, 0xffff0000
    s_mov_b32 s65, 0
    s_or_b32 s68, s33, s36
    s_cselect_b32 s27, 0x7f000000, s52
    s_setprio 1
    buffer_load_dwordx4 v[16:19], v144, s[60:63], s48 offen
    buffer_load_dwordx4 v[20:23], v208, s[60:63], s48 offen
    buffer_load_dwordx4 v[24:27], v209, s[60:63], s48 offen
    buffer_load_dwordx4 v[28:31], v210, s[60:63], s48 offen
    buffer_load_dwordx4 v[32:35], v211, s[60:63], s48 offen
    buffer_load_dwordx4 v[36:39], v212, s[60:63], s48 offen
    buffer_load_dwordx4 v[40:43], v213, s[60:63], s48 offen
    buffer_load_dwordx4 v[44:47], v214, s[60:63], s48 offen
    s_waitcnt vmcnt(15)
    v_dot2_f32_bf16 v200, v152, v147, 0
    v_dot2_f32_bf16 v200, v153, v147, v200
    v_dot2_f32_bf16 v200, v154, v147, v200
    v_dot2_f32_bf16 v200, v155, v147, v200
    s_waitcnt vmcnt(14)
    v_dot2_f32_bf16 v200, v156, v147, v200
    v_dot2_f32_bf16 v200, v157, v147, v200
    v_dot2_f32_bf16 v200, v158, v147, v200
    v_dot2_f32_bf16 v200, v159, v147, v200
    s_waitcnt vmcnt(13)
    v_dot2_f32_bf16 v200, v160, v147, v200
    v_dot2_f32_bf16 v200, v161, v147, v200
    v_dot2_f32_bf16 v200, v162, v147, v200
    v_dot2_f32_bf16 v200, v163, v147, v200
    s_waitcnt vmcnt(12)
    v_dot2_f32_bf16 v200, v164, v147, v200
    v_dot2_f32_bf16 v200, v165, v147, v200
    v_dot2_f32_bf16 v200, v166, v147, v200
    v_dot2_f32_bf16 v200, v167, v147, v200
    s_waitcnt vmcnt(11)
    v_dot2_f32_bf16 v200, v168, v147, v200
    v_dot2_f32_bf16 v200, v169, v147, v200
    v_dot2_f32_bf16 v200, v170, v147, v200
    v_dot2_f32_bf16 v200, v171, v147, v200
    s_waitcnt vmcnt(10)
    v_dot2_f32_bf16 v200, v172, v147, v200
    v_dot2_f32_bf16 v200, v173, v147, v200
    v_dot2_f32_bf16 v200, v174, v147, v200
    v_dot2_f32_bf16 v200, v175, v147, v200
    s_waitcnt vmcnt(9)
    v_dot2_f32_bf16 v200, v176, v147, v200
    v_dot2_f32_bf16 v200, v177, v147, v200
    v_dot2_f32_bf16 v200, v178, v147, v200
    v_dot2_f32_bf16 v200, v179, v147, v200
    s_waitcnt vmcnt(8)
    v_dot2_f32_bf16 v200, v180, v147, v200
    v_dot2_f32_bf16 v200, v181, v147, v200
    v_dot2_f32_bf16 v200, v182, v147, v200
    v_dot2_f32_bf16 v200, v183, v147, v200
    s_nop 2
    v_add_f32_dpp v201, v200, v200 quad_perm:[1,0,3,2] row_mask:0xf bank_mask:0xf
    s_nop 1
    v_add_f32_dpp v200, v201, v201 quad_perm:[2,3,0,1] row_mask:0xf bank_mask:0xf
    s_nop 1
    v_add_f32_dpp v201, v200, v200 row_half_mirror row_mask:0xf bank_mask:0xf
    v_mul_f32 v204, 0xbb000000, v201
    v_dot2_f32_bf16 v184, v152, v148, v204
    v_dot2_f32_bf16 v185, v152, v149, v204
    v_dot2_f32_bf16 v186, v153, v148, v204
    v_dot2_f32_bf16 v187, v153, v149, v204
    v_dot2_f32_bf16 v188, v154, v148, v204
    v_dot2_f32_bf16 v189, v154, v149, v204
    v_dot2_f32_bf16 v190, v155, v148, v204
    v_dot2_f32_bf16 v191, v155, v149, v204
    v_dot2_f32_bf16 v192, v156, v148, v204
    v_dot2_f32_bf16 v193, v156, v149, v204
    v_dot2_f32_bf16 v194, v157, v148, v204
    v_dot2_f32_bf16 v195, v157, v149, v204
    v_dot2_f32_bf16 v196, v158, v148, v204
    v_dot2_f32_bf16 v197, v158, v149, v204
    v_dot2_f32_bf16 v198, v159, v148, v204
    v_dot2_f32_bf16 v199, v159, v149, v204
    v_cvt_pk_bf16_f32 v152, v184, v185
    v_cvt_pk_bf16_f32 v153, v186, v187
    v_cvt_pk_bf16_f32 v154, v188, v189
    v_cvt_pk_bf16_f32 v155, v190, v191
    ds_write_b128 v145, v[152:155]
    v_dot2_f32_bf16 v184, v160, v148, v204
    v_dot2_f32_bf16 v185, v160, v149, v204
    v_dot2_f32_bf16 v186, v161, v148, v204
    v_dot2_f32_bf16 v187, v161, v149, v204
    v_dot2_f32_bf16 v188, v162, v148, v204
    v_dot2_f32_bf16 v189, v162, v149, v204
    v_dot2_f32_bf16 v190, v163, v148, v204
    v_dot2_f32_bf16 v191, v163, v149, v204
    v_dot2_f32_bf16 v202, v152, v152, 0
    v_dot2_f32_bf16 v202, v153, v153, v202
    v_dot2_f32_bf16 v202, v154, v154, v202
    v_dot2_f32_bf16 v202, v155, v155, v202
    v_cvt_pk_bf16_f32 v156, v192, v193
    v_cvt_pk_bf16_f32 v157, v194, v195
    v_cvt_pk_bf16_f32 v158, v196, v197
    v_cvt_pk_bf16_f32 v159, v198, v199
    ds_write_b128 v216, v[156:159]
    v_dot2_f32_bf16 v192, v164, v148, v204
    v_dot2_f32_bf16 v193, v164, v149, v204
    v_dot2_f32_bf16 v194, v165, v148, v204
    v_dot2_f32_bf16 v195, v165, v149, v204
    v_dot2_f32_bf16 v196, v166, v148, v204
    v_dot2_f32_bf16 v197, v166, v149, v204
    v_dot2_f32_bf16 v198, v167, v148, v204
    v_dot2_f32_bf16 v199, v167, v149, v204
    v_dot2_f32_bf16 v202, v156, v156, v202
    v_dot2_f32_bf16 v202, v157, v157, v202
    v_dot2_f32_bf16 v202, v158, v158, v202
    v_dot2_f32_bf16 v202, v159, v159, v202
    v_cvt_pk_bf16_f32 v160, v184, v185
    v_cvt_pk_bf16_f32 v161, v186, v187
    v_cvt_pk_bf16_f32 v162, v188, v189
    v_cvt_pk_bf16_f32 v163, v190, v191
    ds_write_b128 v217, v[160:163]
    v_dot2_f32_bf16 v184, v168, v148, v204
    v_dot2_f32_bf16 v185, v168, v149, v204
    v_dot2_f32_bf16 v186, v169, v148, v204
    v_dot2_f32_bf16 v187, v169, v149, v204
    v_dot2_f32_bf16 v188, v170, v148, v204
    v_dot2_f32_bf16 v189, v170, v149, v204
    v_dot2_f32_bf16 v190, v171, v148, v204
    v_dot2_f32_bf16 v191, v171, v149, v204
    v_dot2_f32_bf16 v202, v160, v160, v202
    v_dot2_f32_bf16 v202, v161, v161, v202
    v_dot2_f32_bf16 v202, v162, v162, v202
    v_dot2_f32_bf16 v202, v163, v163, v202
    v_cvt_pk_bf16_f32 v164, v192, v193
    v_cvt_pk_bf16_f32 v165, v194, v195
    v_cvt_pk_bf16_f32 v166, v196, v197
    v_cvt_pk_bf16_f32 v167, v198, v199
    ds_write_b128 v218, v[164:167]
    v_dot2_f32_bf16 v192, v172, v148, v204
    v_dot2_f32_bf16 v193, v172, v149, v204
    v_dot2_f32_bf16 v194, v173, v148, v204
    v_dot2_f32_bf16 v195, v173, v149, v204
    v_dot2_f32_bf16 v196, v174, v148, v204
    v_dot2_f32_bf16 v197, v174, v149, v204
    v_dot2_f32_bf16 v198, v175, v148, v204
    v_dot2_f32_bf16 v199, v175, v149, v204
    v_dot2_f32_bf16 v202, v164, v164, v202
    v_dot2_f32_bf16 v202, v165, v165, v202
    v_dot2_f32_bf16 v202, v166, v166, v202
    v_dot2_f32_bf16 v202, v167, v167, v202
    v_cvt_pk_bf16_f32 v168, v184, v185
    v_cvt_pk_bf16_f32 v169, v186, v187
    v_cvt_pk_bf16_f32 v170, v188, v189
    v_cvt_pk_bf16_f32 v171, v190, v191
    ds_write_b128 v219, v[168:171]
    v_dot2_f32_bf16 v184, v176, v148, v204
    v_dot2_f32_bf16 v185, v176, v149, v204
    v_dot2_f32_bf16 v186, v177, v148, v204
    v_dot2_f32_bf16 v187, v177, v149, v204
    v_dot2_f32_bf16 v188, v178, v148, v204
    v_dot2_f32_bf16 v189, v178, v149, v204
    v_dot2_f32_bf16 v190, v179, v148, v204
    v_dot2_f32_bf16 v191, v179, v149, v204
    v_dot2_f32_bf16 v202, v168, v168, v202
    v_dot2_f32_bf16 v202, v169, v169, v202
    v_dot2_f32_bf16 v202, v170, v170, v202
    v_dot2_f32_bf16 v202, v171, v171, v202
    v_cvt_pk_bf16_f32 v172, v192, v193
    v_cvt_pk_bf16_f32 v173, v194, v195
    v_cvt_pk_bf16_f32 v174, v196, v197
    v_cvt_pk_bf16_f32 v175, v198, v199
    ds_write_b128 v220, v[172:175]
    v_dot2_f32_bf16 v192, v180, v148, v204
    v_dot2_f32_bf16 v193, v180, v149, v204
    v_dot2_f32_bf16 v194, v181, v148, v204
    v_dot2_f32_bf16 v195, v181, v149, v204
    v_dot2_f32_bf16 v196, v182, v148, v204
    v_dot2_f32_bf16 v197, v182, v149, v204
    v_dot2_f32_bf16 v198, v183, v148, v204
    v_dot2_f32_bf16 v199, v183, v149, v204
    v_dot2_f32_bf16 v202, v172, v172, v202
    v_dot2_f32_bf16 v202, v173, v173, v202
    v_dot2_f32_bf16 v202, v174, v174, v202
    v_dot2_f32_bf16 v202, v175, v175, v202
    v_cvt_pk_bf16_f32 v176, v184, v185
    v_cvt_pk_bf16_f32 v177, v186, v187
    v_cvt_pk_bf16_f32 v178, v188, v189
    v_cvt_pk_bf16_f32 v179, v190, v191
    ds_write_b128 v221, v[176:179]
    v_dot2_f32_bf16 v202, v176, v176, v202
    v_dot2_f32_bf16 v202, v177, v177, v202
    v_dot2_f32_bf16 v202, v178, v178, v202
    v_dot2_f32_bf16 v202, v179, v179, v202
    v_cvt_pk_bf16_f32 v180, v192, v193
    v_cvt_pk_bf16_f32 v181, v194, v195
    v_cvt_pk_bf16_f32 v182, v196, v197
    v_cvt_pk_bf16_f32 v183, v198, v199
    ds_write_b128 v222, v[180:183]
    v_dot2_f32_bf16 v202, v180, v180, v202
    v_dot2_f32_bf16 v202, v181, v181, v202
    v_dot2_f32_bf16 v202, v182, v182, v202
    v_dot2_f32_bf16 v202, v183, v183, v202
    s_nop 2
    v_add_f32_dpp v205, v202, v202 quad_perm:[1,0,3,2] row_mask:0xf bank_mask:0xf
    s_nop 1
    v_add_f32_dpp v202, v205, v205 quad_perm:[2,3,0,1] row_mask:0xf bank_mask:0xf
    s_nop 1
    v_add_f32_dpp v205, v202, v202 row_half_mirror row_mask:0xf bank_mask:0xf
    s_mov_b32 exec_lo, 0x01010101
    s_mov_b32 exec_hi, 0x01010101
    ds_write_b64 v146, v[204:205]
    s_mov_b64 exec, -1
    s_waitcnt vmcnt(7)
    v_dot2_f32_bf16 v200, v16, v147, 0
    v_dot2_f32_bf16 v200, v17, v147, v200
    v_dot2_f32_bf16 v200, v18, v147, v200
    v_dot2_f32_bf16 v200, v19, v147, v200
    s_waitcnt vmcnt(6)
    v_dot2_f32_bf16 v200, v20, v147, v200
    v_dot2_f32_bf16 v200, v21, v147, v200
    v_dot2_f32_bf16 v200, v22, v147, v200
    v_dot2_f32_bf16 v200, v23, v147, v200
    s_waitcnt vmcnt(5)
    v_dot2_f32_bf16 v200, v24, v147, v200
    v_dot2_f32_bf16 v200, v25, v147, v200
    v_dot2_f32_bf16 v200, v26, v147, v200
    v_dot2_f32_bf16 v200, v27, v147, v200
    s_waitcnt vmcnt(4)
    v_dot2_f32_bf16 v200, v28, v147, v200
    v_dot2_f32_bf16 v200, v29, v147, v200
    v_dot2_f32_bf16 v200, v30, v147, v200
    v_dot2_f32_bf16 v200, v31, v147, v200
    s_waitcnt vmcnt(3)
    v_dot2_f32_bf16 v200, v32, v147, v200
    v_dot2_f32_bf16 v200, v33, v147, v200
    v_dot2_f32_bf16 v200, v34, v147, v200
    v_dot2_f32_bf16 v200, v35, v147, v200
    s_waitcnt vmcnt(2)
    v_dot2_f32_bf16 v200, v36, v147, v200
    v_dot2_f32_bf16 v200, v37, v147, v200
    v_dot2_f32_bf16 v200, v38, v147, v200
    v_dot2_f32_bf16 v200, v39, v147, v200
    s_waitcnt vmcnt(1)
    v_dot2_f32_bf16 v200, v40, v147, v200
    v_dot2_f32_bf16 v200, v41, v147, v200
    v_dot2_f32_bf16 v200, v42, v147, v200
    v_dot2_f32_bf16 v200, v43, v147, v200
    s_waitcnt vmcnt(0)
    v_dot2_f32_bf16 v200, v44, v147, v200
    v_dot2_f32_bf16 v200, v45, v147, v200
    v_dot2_f32_bf16 v200, v46, v147, v200
    v_dot2_f32_bf16 v200, v47, v147, v200
    v_xor_b32 v145, 512, v145
    v_xor_b32 v146, 512, v146
    v_xor_b32 v216, 512, v216
    v_xor_b32 v217, 512, v217
    v_xor_b32 v218, 512, v218
    v_xor_b32 v219, 512, v219
    v_xor_b32 v220, 512, v220
    v_xor_b32 v221, 512, v221
    v_xor_b32 v222, 512, v222
    v_add_f32_dpp v201, v200, v200 quad_perm:[1,0,3,2] row_mask:0xf bank_mask:0xf
    s_nop 1
    v_add_f32_dpp v200, v201, v201 quad_perm:[2,3,0,1] row_mask:0xf bank_mask:0xf
    s_nop 1
    v_add_f32_dpp v201, v200, v200 row_half_mirror row_mask:0xf bank_mask:0xf
    v_mul_f32 v204, 0xbb000000, v201
    v_dot2_f32_bf16 v184, v16, v148, v204
    v_dot2_f32_bf16 v185, v16, v149, v204
    v_dot2_f32_bf16 v186, v17, v148, v204
    v_dot2_f32_bf16 v187, v17, v149, v204
    v_dot2_f32_bf16 v188, v18, v148, v204
    v_dot2_f32_bf16 v189, v18, v149, v204
    v_dot2_f32_bf16 v190, v19, v148, v204
    v_dot2_f32_bf16 v191, v19, v149, v204
    v_dot2_f32_bf16 v192, v20, v148, v204
    v_dot2_f32_bf16 v193, v20, v149, v204
    v_dot2_f32_bf16 v194, v21, v148, v204
    v_dot2_f32_bf16 v195, v21, v149, v204
    v_dot2_f32_bf16 v196, v22, v148, v204
    v_dot2_f32_bf16 v197, v22, v149, v204
    v_dot2_f32_bf16 v198, v23, v148, v204
    v_dot2_f32_bf16 v199, v23, v149, v204
    v_cvt_pk_bf16_f32 v16, v184, v185
    v_cvt_pk_bf16_f32 v17, v186, v187
    v_cvt_pk_bf16_f32 v18, v188, v189
    v_cvt_pk_bf16_f32 v19, v190, v191
    ds_write_b128 v145, v[16:19]
    v_dot2_f32_bf16 v184, v24, v148, v204
    v_dot2_f32_bf16 v185, v24, v149, v204
    v_dot2_f32_bf16 v186, v25, v148, v204
    v_dot2_f32_bf16 v187, v25, v149, v204
    v_dot2_f32_bf16 v188, v26, v148, v204
    v_dot2_f32_bf16 v189, v26, v149, v204
    v_dot2_f32_bf16 v190, v27, v148, v204
    v_dot2_f32_bf16 v191, v27, v149, v204
    v_dot2_f32_bf16 v202, v16, v16, 0
    v_dot2_f32_bf16 v202, v17, v17, v202
    v_dot2_f32_bf16 v202, v18, v18, v202
    v_dot2_f32_bf16 v202, v19, v19, v202
    v_cvt_pk_bf16_f32 v20, v192, v193
    v_cvt_pk_bf16_f32 v21, v194, v195
    v_cvt_pk_bf16_f32 v22, v196, v197
    v_cvt_pk_bf16_f32 v23, v198, v199
    ds_write_b128 v216, v[20:23]
    v_dot2_f32_bf16 v192, v28, v148, v204
    v_dot2_f32_bf16 v193, v28, v149, v204
    v_dot2_f32_bf16 v194, v29, v148, v204
    v_dot2_f32_bf16 v195, v29, v149, v204
    v_dot2_f32_bf16 v196, v30, v148, v204
    v_dot2_f32_bf16 v197, v30, v149, v204
    v_dot2_f32_bf16 v198, v31, v148, v204
    v_dot2_f32_bf16 v199, v31, v149, v204
    v_dot2_f32_bf16 v202, v20, v20, v202
    v_dot2_f32_bf16 v202, v21, v21, v202
    v_dot2_f32_bf16 v202, v22, v22, v202
    v_dot2_f32_bf16 v202, v23, v23, v202
    v_cvt_pk_bf16_f32 v24, v184, v185
    v_cvt_pk_bf16_f32 v25, v186, v187
    v_cvt_pk_bf16_f32 v26, v188, v189
    v_cvt_pk_bf16_f32 v27, v190, v191
    ds_write_b128 v217, v[24:27]
    v_dot2_f32_bf16 v184, v32, v148, v204
    v_dot2_f32_bf16 v185, v32, v149, v204
    v_dot2_f32_bf16 v186, v33, v148, v204
    v_dot2_f32_bf16 v187, v33, v149, v204
    v_dot2_f32_bf16 v188, v34, v148, v204
    v_dot2_f32_bf16 v189, v34, v149, v204
    v_dot2_f32_bf16 v190, v35, v148, v204
    v_dot2_f32_bf16 v191, v35, v149, v204
    v_dot2_f32_bf16 v202, v24, v24, v202
    v_dot2_f32_bf16 v202, v25, v25, v202
    v_dot2_f32_bf16 v202, v26, v26, v202
    v_dot2_f32_bf16 v202, v27, v27, v202
    v_cvt_pk_bf16_f32 v28, v192, v193
    v_cvt_pk_bf16_f32 v29, v194, v195
    v_cvt_pk_bf16_f32 v30, v196, v197
    v_cvt_pk_bf16_f32 v31, v198, v199
    ds_write_b128 v218, v[28:31]
    v_dot2_f32_bf16 v192, v36, v148, v204
    v_dot2_f32_bf16 v193, v36, v149, v204
    v_dot2_f32_bf16 v194, v37, v148, v204
    v_dot2_f32_bf16 v195, v37, v149, v204
    v_dot2_f32_bf16 v196, v38, v148, v204
    v_dot2_f32_bf16 v197, v38, v149, v204
    v_dot2_f32_bf16 v198, v39, v148, v204
    v_dot2_f32_bf16 v199, v39, v149, v204
    v_dot2_f32_bf16 v202, v28, v28, v202
    v_dot2_f32_bf16 v202, v29, v29, v202
    v_dot2_f32_bf16 v202, v30, v30, v202
    v_dot2_f32_bf16 v202, v31, v31, v202
    v_cvt_pk_bf16_f32 v32, v184, v185
    v_cvt_pk_bf16_f32 v33, v186, v187
    v_cvt_pk_bf16_f32 v34, v188, v189
    v_cvt_pk_bf16_f32 v35, v190, v191
    ds_write_b128 v219, v[32:35]
    v_dot2_f32_bf16 v184, v40, v148, v204
    v_dot2_f32_bf16 v185, v40, v149, v204
    v_dot2_f32_bf16 v186, v41, v148, v204
    v_dot2_f32_bf16 v187, v41, v149, v204
    v_dot2_f32_bf16 v188, v42, v148, v204
    v_dot2_f32_bf16 v189, v42, v149, v204
    v_dot2_f32_bf16 v190, v43, v148, v204
    v_dot2_f32_bf16 v191, v43, v149, v204
    v_dot2_f32_bf16 v202, v32, v32, v202
    v_dot2_f32_bf16 v202, v33, v33, v202
    v_dot2_f32_bf16 v202, v34, v34, v202
    v_dot2_f32_bf16 v202, v35, v35, v202
    v_cvt_pk_bf16_f32 v36, v192, v193
    v_cvt_pk_bf16_f32 v37, v194, v195
    v_cvt_pk_bf16_f32 v38, v196, v197
    v_cvt_pk_bf16_f32 v39, v198, v199
    ds_write_b128 v220, v[36:39]
    v_dot2_f32_bf16 v192, v44, v148, v204
    v_dot2_f32_bf16 v193, v44, v149, v204
    v_dot2_f32_bf16 v194, v45, v148, v204
    v_dot2_f32_bf16 v195, v45, v149, v204
    v_dot2_f32_bf16 v196, v46, v148, v204
    v_dot2_f32_bf16 v197, v46, v149, v204
    v_dot2_f32_bf16 v198, v47, v148, v204
    v_dot2_f32_bf16 v199, v47, v149, v204
    v_dot2_f32_bf16 v202, v36, v36, v202
    v_dot2_f32_bf16 v202, v37, v37, v202
    v_dot2_f32_bf16 v202, v38, v38, v202
    v_dot2_f32_bf16 v202, v39, v39, v202
    v_cvt_pk_bf16_f32 v40, v184, v185
    v_cvt_pk_bf16_f32 v41, v186, v187
    v_cvt_pk_bf16_f32 v42, v188, v189
    v_cvt_pk_bf16_f32 v43, v190, v191
    ds_write_b128 v221, v[40:43]
    v_dot2_f32_bf16 v202, v40, v40, v202
    v_dot2_f32_bf16 v202, v41, v41, v202
    v_dot2_f32_bf16 v202, v42, v42, v202
    v_dot2_f32_bf16 v202, v43, v43, v202
    v_cvt_pk_bf16_f32 v44, v192, v193
    v_cvt_pk_bf16_f32 v45, v194, v195
    v_cvt_pk_bf16_f32 v46, v196, v197
    v_cvt_pk_bf16_f32 v47, v198, v199
    ds_write_b128 v222, v[44:47]
    v_dot2_f32_bf16 v202, v44, v44, v202
    v_dot2_f32_bf16 v202, v45, v45, v202
    v_dot2_f32_bf16 v202, v46, v46, v202
    v_dot2_f32_bf16 v202, v47, v47, v202
    s_nop 2
    v_add_f32_dpp v205, v202, v202 quad_perm:[1,0,3,2] row_mask:0xf bank_mask:0xf
    s_nop 1
    v_add_f32_dpp v202, v205, v205 quad_perm:[2,3,0,1] row_mask:0xf bank_mask:0xf
    s_nop 1
    v_add_f32_dpp v205, v202, v202 row_half_mirror row_mask:0xf bank_mask:0xf
    s_mov_b32 exec_lo, 0x01010101
    s_mov_b32 exec_hi, 0x01010101
    ds_write_b64 v146, v[204:205]
    s_mov_b64 exec, -1
    global_load_ushort v104, v85, s[20:21]
    global_load_ushort v105, v85, s[20:21] offset:128
    global_load_ushort v106, v86, s[20:21]
    s_setprio 1
    s_waitcnt lgkmcnt(0)
    s_barrier
    ds_read_b64 v[84:85], v15
    ds_read_b64 v[86:87], v15 offset:256
    ds_read_b128 v[128:131], v11 offset:0
    s_add_u32 s28, s28, 0x9e3779b9
    s_mov_b32 s29, s28
    ds_read_b128 v[132:135], v11 offset:256
    v_mov_b32 v6, s28
    s_lshl_b32 s69, s36, 10
    ds_read_b128 v[136:139], v12 offset:4096
    v_mov_b32 v73, 0
    v_mov_b32 v74, 0
    ds_read_b128 v[140:143], v12 offset:4352
    v_mov_b32 v75, 0
    ds_read_b128 v[144:147], v11 offset:8192
    ds_read_b128 v[148:151], v11 offset:8448
    ds_read_b128 v[152:155], v12 offset:12288
    ds_read_b128 v[156:159], v12 offset:12544
    s_waitcnt lgkmcnt(8)
    v_mul_f32 v85, 0x3b000000, v85
    v_mul_f32 v87, 0x3b000000, v87
    ds_read_b128 v[160:163], v11 offset:16384
    v_cvt_pk_bf16_f32 v80, v85, v85
    v_cvt_pk_bf16_f32 v82, v87, v87
    ds_read_b128 v[164:167], v11 offset:16640
    v_and_b32 v80, 0xffff0000, v80
    v_and_b32 v82, 0xffff0000, v82
    ds_read_b128 v[168:171], v12 offset:20480
    v_add_f32 v80, 0x3727c5ac, v80
    v_add_f32 v82, 0x3727c5ac, v82
    ds_read_b128 v[172:175], v12 offset:20736
    v_cvt_pk_bf16_f32 v80, v80, v80
    v_cvt_pk_bf16_f32 v82, v82, v82
    ds_read_b128 v[176:179], v11 offset:24576
    v_and_b32 v80, 0xffff0000, v80
    v_and_b32 v82, 0xffff0000, v82
    ds_read_b128 v[180:183], v11 offset:24832
    v_sqrt_f32 v80, v80
    v_sqrt_f32 v82, v82
    ds_read_b128 v[184:187], v12 offset:28672
    v_cvt_pk_bf16_f32 v80, v80, v80
    v_cvt_pk_bf16_f32 v82, v82, v82
    ds_read_b128 v[188:191], v12 offset:28928
    v_and_b32 v80, 0xffff0000, v80
    v_and_b32 v82, 0xffff0000, v82
    ds_read_b128 v[192:195], v11 offset:32768
    v_rcp_f32 v81, v80
    v_rcp_f32 v83, v82
    ds_read_b128 v[196:199], v11 offset:33024
    v_mul_f32 v81, v81, v81
    v_mul_f32 v83, v83, v83
    ds_read_b128 v[200:203], v12 offset:36864
    v_mul_f32 v81, v81, v85
    v_mul_f32 v83, v83, v87
    ds_read_b128 v[204:207], v12 offset:37120
    v_cvt_pk_bf16_f32 v81, v81, v81
    v_cvt_pk_bf16_f32 v83, v83, v83
    ds_read_b128 v[208:211], v11 offset:40960
    v_and_b32 v81, 0xffff0000, v81
    v_and_b32 v83, 0xffff0000, v83
    ds_read_b128 v[212:215], v11 offset:41216
    v_add_f32 v81, 0x3727c5ac, v81
    v_add_f32 v83, 0x3727c5ac, v83
    ds_read_b128 v[216:219], v12 offset:45056
    v_cvt_pk_bf16_f32 v81, v81, v81
    v_cvt_pk_bf16_f32 v83, v83, v83
    ds_read_b128 v[220:223], v12 offset:45312
    v_and_b32 v81, 0xffff0000, v81
    v_and_b32 v83, 0xffff0000, v83
    ds_read_b128 v[224:227], v11 offset:49152
    v_sqrt_f32 v81, v81
    v_sqrt_f32 v83, v83
    ds_read_b128 v[228:231], v11 offset:49408
    v_cvt_pk_bf16_f32 v81, v81, v81
    v_cvt_pk_bf16_f32 v83, v83, v83
    ds_read_b128 v[232:235], v12 offset:53248
    v_and_b32 v81, 0xffff0000, v81
    v_and_b32 v83, 0xffff0000, v83
    ds_read_b128 v[236:239], v12 offset:53504
    v_mul_f32 v110, v80, v81
    v_mul_f32 v114, v82, v83
    ds_read_b128 v[240:243], v11 offset:57344
    v_rcp_f32 v80, v110
    v_rcp_f32 v82, v114
    ds_read_b128 v[244:247], v11 offset:57600
    v_cvt_pk_bf16_f32 v81, v110, v110
    v_cvt_pk_bf16_f32 v83, v114, v114
    ds_read_b128 v[248:251], v12 offset:61440
    v_and_b32 v81, 0xffff0000, v81
    v_and_b32 v83, 0xffff0000, v83
    ds_read_b128 v[252:255], v12 offset:61696
    v_mul_f32 v109, 0xc0135761, v80
    v_mul_f32 v113, 0xc0135761, v82
    v_mul_f32 v80, v80, v80
    v_mul_f32 v82, v82, v82
    v_mul_f32 v80, v80, v109
    v_mul_f32 v82, v82, v113
    v_mul_f32 v108, 0x3d372713, v80
    v_mul_f32 v112, 0x3d372713, v82
    v_sub_f32 v80, v110, v81
    v_sub_f32 v82, v114, v83
    v_cvt_pk_bf16_f32 v81, v81, v80
    v_cvt_pk_bf16_f32 v83, v83, v82
    v_cndmask_b32 v96, 0, v81, s[58:59]
    v_cndmask_b32 v100, 0, v83, s[58:59]
    v_cndmask_b32 v98, 0, v81, s[64:65]
    v_cndmask_b32 v102, 0, v83, s[64:65]
    v_mov_b32 v97, 0
    v_mov_b32 v101, 0
    v_mov_b32 v99, 0
    v_mov_b32 v103, 0
    s_waitcnt vmcnt(0) lgkmcnt(0)
    v_lshl_or_b32 v104, v104, 16, v104
    v_lshl_or_b32 v105, v105, 16, v105
    v_lshl_or_b32 v106, v106, 16, v106
    v_mov_b32 v72, v104
    v_xor_b32 v119, 32, v116
    s_barrier
    ds_read_b64_tr_b16 v[48:49], v116 offset:0
    ds_read_b64_tr_b16 v[50:51], v116 offset:256
    ds_read_b64_tr_b16 v[52:53], v119 offset:0
    ds_read_b64_tr_b16 v[54:55], v119 offset:256
    ds_read_b64_tr_b16 v[56:57], v116 offset:2048
    ds_read_b64_tr_b16 v[58:59], v116 offset:2304
    ds_read_b64_tr_b16 v[60:61], v119 offset:2048
    ds_read_b64_tr_b16 v[62:63], v119 offset:2304
    ds_read_b64_tr_b16 v[64:65], v116 offset:8192
    ds_read_b64_tr_b16 v[66:67], v116 offset:8448
    ds_read_b64_tr_b16 v[68:69], v119 offset:8192
    ds_read_b64_tr_b16 v[70:71], v119 offset:8448
    v_mfma_f32_16x16x32_bf16 v[16:19], v[72:75], v[96:99], 0
    v_mfma_f32_16x16x32_bf16 v[20:23], v[72:75], v[98:101], 0
    v_mfma_f32_16x16x32_bf16 v[24:27], v[72:75], v[100:103], 0
    v_mfma_f32_16x16x32_bf16 v[28:31], v[72:75], v[102:105], 0
    v_mov_b32 v72, v105
    s_waitcnt lgkmcnt(8)
    v_mfma_f32_16x16x32_bf16 v[16:19], v[48:51], v[128:131], v[16:19]
    v_mfma_f32_16x16x32_bf16 v[24:27], v[48:51], v[132:135], v[24:27]
    ds_read_b64_tr_b16 v[48:49], v116 offset:10240
    v_mfma_f32_16x16x32_bf16 v[28:31], v[52:55], v[132:135], v[28:31]
    ds_read_b64_tr_b16 v[50:51], v116 offset:10496
    v_mfma_f32_16x16x32_bf16 v[20:23], v[52:55], v[128:131], v[20:23]
    ds_read_b64_tr_b16 v[52:53], v119 offset:10240
    s_waitcnt lgkmcnt(7)
    v_mfma_f32_16x16x32_bf16 v[16:19], v[56:59], v[136:139], v[16:19]
    ds_read_b64_tr_b16 v[54:55], v119 offset:10496
    v_mfma_f32_16x16x32_bf16 v[24:27], v[56:59], v[140:143], v[24:27]
    ds_read_b64_tr_b16 v[56:57], v116 offset:16384
    v_mfma_f32_16x16x32_bf16 v[28:31], v[60:63], v[140:143], v[28:31]
    ds_read_b64_tr_b16 v[58:59], v116 offset:16640
    v_mfma_f32_16x16x32_bf16 v[20:23], v[60:63], v[136:139], v[20:23]
    ds_read_b64_tr_b16 v[60:61], v119 offset:16384
    s_waitcnt lgkmcnt(7)
    v_mfma_f32_16x16x32_bf16 v[16:19], v[64:67], v[160:163], v[16:19]
    ds_read_b64_tr_b16 v[62:63], v119 offset:16640
    v_mfma_f32_16x16x32_bf16 v[24:27], v[64:67], v[164:167], v[24:27]
    ds_read_b64_tr_b16 v[64:65], v116 offset:18432
    v_mfma_f32_16x16x32_bf16 v[28:31], v[68:71], v[164:167], v[28:31]
    ds_read_b64_tr_b16 v[66:67], v116 offset:18688
    v_mfma_f32_16x16x32_bf16 v[20:23], v[68:71], v[160:163], v[20:23]
    ds_read_b64_tr_b16 v[68:69], v119 offset:18432
    s_waitcnt lgkmcnt(7)
    v_mfma_f32_16x16x32_bf16 v[16:19], v[48:51], v[168:171], v[16:19]
    ds_read_b64_tr_b16 v[70:71], v119 offset:18688
    v_mfma_f32_16x16x32_bf16 v[24:27], v[48:51], v[172:175], v[24:27]
    ds_read_b64_tr_b16 v[48:49], v116 offset:24576
    v_mfma_f32_16x16x32_bf16 v[28:31], v[52:55], v[172:175], v[28:31]
    ds_read_b64_tr_b16 v[50:51], v116 offset:24832
    v_mfma_f32_16x16x32_bf16 v[20:23], v[52:55], v[168:171], v[20:23]
    ds_read_b64_tr_b16 v[52:53], v119 offset:24576
    s_waitcnt lgkmcnt(7)
    v_mfma_f32_16x16x32_bf16 v[16:19], v[56:59], v[192:195], v[16:19]
    ds_read_b64_tr_b16 v[54:55], v119 offset:24832
    v_mfma_f32_16x16x32_bf16 v[24:27], v[56:59], v[196:199], v[24:27]
    ds_read_b64_tr_b16 v[56:57], v116 offset:26624
    v_mfma_f32_16x16x32_bf16 v[28:31], v[60:63], v[196:199], v[28:31]
    ds_read_b64_tr_b16 v[58:59], v116 offset:26880
    v_mfma_f32_16x16x32_bf16 v[20:23], v[60:63], v[192:195], v[20:23]
    ds_read_b64_tr_b16 v[60:61], v119 offset:26624
    s_waitcnt lgkmcnt(7)
    v_mfma_f32_16x16x32_bf16 v[16:19], v[64:67], v[200:203], v[16:19]
    ds_read_b64_tr_b16 v[62:63], v119 offset:26880
    v_mfma_f32_16x16x32_bf16 v[24:27], v[64:67], v[204:207], v[24:27]
    v_mfma_f32_16x16x32_bf16 v[28:31], v[68:71], v[204:207], v[28:31]
    v_mfma_f32_16x16x32_bf16 v[20:23], v[68:71], v[200:203], v[20:23]
    s_barrier
    ds_read_b64_tr_b16 v[64:65], v116 offset:4096
    ds_read_b64_tr_b16 v[66:67], v116 offset:4352
    ds_read_b64_tr_b16 v[68:69], v119 offset:4096
    ds_read_b64_tr_b16 v[70:71], v119 offset:4352
    s_waitcnt lgkmcnt(8)
    v_mfma_f32_16x16x32_bf16 v[16:19], v[48:51], v[224:227], v[16:19]
    v_mfma_f32_16x16x32_bf16 v[24:27], v[48:51], v[228:231], v[24:27]
    ds_read_b64_tr_b16 v[48:49], v116 offset:6144
    v_mfma_f32_16x16x32_bf16 v[28:31], v[52:55], v[228:231], v[28:31]
    ds_read_b64_tr_b16 v[50:51], v116 offset:6400
    v_mfma_f32_16x16x32_bf16 v[20:23], v[52:55], v[224:227], v[20:23]
    ds_read_b64_tr_b16 v[52:53], v119 offset:6144
    s_waitcnt lgkmcnt(7)
    v_mfma_f32_16x16x32_bf16 v[16:19], v[56:59], v[232:235], v[16:19]
    ds_read_b64_tr_b16 v[54:55], v119 offset:6400
    v_mfma_f32_16x16x32_bf16 v[24:27], v[56:59], v[236:239], v[24:27]
    ds_read_b64_tr_b16 v[56:57], v116 offset:12288
    v_mfma_f32_16x16x32_bf16 v[28:31], v[60:63], v[236:239], v[28:31]
    ds_read_b64_tr_b16 v[58:59], v116 offset:12544
    v_mfma_f32_16x16x32_bf16 v[20:23], v[60:63], v[232:235], v[20:23]
    ds_read_b64_tr_b16 v[60:61], v119 offset:12288
    s_waitcnt lgkmcnt(7)
    v_mfma_f32_16x16x32_bf16 v[16:19], v[64:67], v[144:147], v[16:19]
    ds_read_b64_tr_b16 v[62:63], v119 offset:12544
    v_mfma_f32_16x16x32_bf16 v[24:27], v[64:67], v[148:151], v[24:27]
    ds_read_b64_tr_b16 v[64:65], v116 offset:14336
    v_mfma_f32_16x16x32_bf16 v[28:31], v[68:71], v[148:151], v[28:31]
    ds_read_b64_tr_b16 v[66:67], v116 offset:14592
    v_mfma_f32_16x16x32_bf16 v[20:23], v[68:71], v[144:147], v[20:23]
    ds_read_b64_tr_b16 v[68:69], v119 offset:14336
    s_waitcnt lgkmcnt(7)
    v_mfma_f32_16x16x32_bf16 v[16:19], v[48:51], v[152:155], v[16:19]
    ds_read_b64_tr_b16 v[70:71], v119 offset:14592
    v_mfma_f32_16x16x32_bf16 v[24:27], v[48:51], v[156:159], v[24:27]
    ds_read_b64_tr_b16 v[48:49], v116 offset:20480
    v_mfma_f32_16x16x32_bf16 v[28:31], v[52:55], v[156:159], v[28:31]
    ds_read_b64_tr_b16 v[50:51], v116 offset:20736
    v_mfma_f32_16x16x32_bf16 v[20:23], v[52:55], v[152:155], v[20:23]
    ds_read_b64_tr_b16 v[52:53], v119 offset:20480
    s_waitcnt lgkmcnt(7)
    v_mfma_f32_16x16x32_bf16 v[16:19], v[56:59], v[176:179], v[16:19]
    ds_read_b64_tr_b16 v[54:55], v119 offset:20736
    v_mfma_f32_16x16x32_bf16 v[24:27], v[56:59], v[180:183], v[24:27]
    ds_read_b64_tr_b16 v[56:57], v116 offset:22528
    v_mfma_f32_16x16x32_bf16 v[28:31], v[60:63], v[180:183], v[28:31]
    ds_read_b64_tr_b16 v[58:59], v116 offset:22784
    v_mfma_f32_16x16x32_bf16 v[20:23], v[60:63], v[176:179], v[20:23]
    ds_read_b64_tr_b16 v[60:61], v119 offset:22528
    s_waitcnt lgkmcnt(7)
    v_mfma_f32_16x16x32_bf16 v[16:19], v[64:67], v[184:187], v[16:19]
    ds_read_b64_tr_b16 v[62:63], v119 offset:22784
    v_mfma_f32_16x16x32_bf16 v[24:27], v[64:67], v[188:191], v[24:27]
    ds_read_b64_tr_b16 v[64:65], v116 offset:28672
    v_mfma_f32_16x16x32_bf16 v[28:31], v[68:71], v[188:191], v[28:31]
    ds_read_b64_tr_b16 v[66:67], v116 offset:28928
    v_mfma_f32_16x16x32_bf16 v[20:23], v[68:71], v[184:187], v[20:23]
    ds_read_b64_tr_b16 v[68:69], v119 offset:28672
    s_waitcnt lgkmcnt(7)
    v_mfma_f32_16x16x32_bf16 v[16:19], v[48:51], v[208:211], v[16:19]
    ds_read_b64_tr_b16 v[70:71], v119 offset:28928
    v_mfma_f32_16x16x32_bf16 v[24:27], v[48:51], v[212:215], v[24:27]
    ds_read_b64_tr_b16 v[48:49], v116 offset:30720
    v_mfma_f32_16x16x32_bf16 v[28:31], v[52:55], v[212:215], v[28:31]
    ds_read_b64_tr_b16 v[50:51], v116 offset:30976
    v_mfma_f32_16x16x32_bf16 v[20:23], v[52:55], v[208:211], v[20:23]
    ds_read_b64_tr_b16 v[52:53], v119 offset:30720
    s_waitcnt lgkmcnt(7)
    v_mfma_f32_16x16x32_bf16 v[16:19], v[56:59], v[216:219], v[16:19]
    ds_read_b64_tr_b16 v[54:55], v119 offset:30976
    v_mfma_f32_16x16x32_bf16 v[24:27], v[56:59], v[220:223], v[24:27]
    v_mfma_f32_16x16x32_bf16 v[28:31], v[60:63], v[220:223], v[28:31]
    v_mfma_f32_16x16x32_bf16 v[20:23], v[60:63], v[216:219], v[20:23]
    s_waitcnt lgkmcnt(4)
    v_mfma_f32_16x16x32_bf16 v[16:19], v[64:67], v[240:243], v[16:19]
    v_mfma_f32_16x16x32_bf16 v[24:27], v[64:67], v[244:247], v[24:27]
    v_mfma_f32_16x16x32_bf16 v[28:31], v[68:71], v[244:247], v[28:31]
    v_mfma_f32_16x16x32_bf16 v[20:23], v[68:71], v[240:243], v[20:23]
    s_waitcnt lgkmcnt(0)
    v_mfma_f32_16x16x32_bf16 v[16:19], v[48:51], v[248:251], v[16:19]
    v_mfma_f32_16x16x32_bf16 v[24:27], v[48:51], v[252:255], v[24:27]
    v_mfma_f32_16x16x32_bf16 v[28:31], v[52:55], v[252:255], v[28:31]
    v_mfma_f32_16x16x32_bf16 v[20:23], v[52:55], v[248:251], v[20:23]
    s_nop 4
    v_pk_mul_f32 v[80:81], v[16:17], v[16:17]
    v_pk_mul_f32 v[82:83], v[18:19], v[18:19]
    s_nop 0
    v_pk_mul_f32 v[84:85], v[20:21], v[20:21]
    v_pk_mul_f32 v[86:87], v[22:23], v[22:23]
    v_pk_fma_f32 v[80:81], v[80:81], v[108:109], v[108:109] op_sel:[0,0,1] op_sel_hi:[1,0,1]
    v_pk_fma_f32 v[82:83], v[82:83], v[108:109], v[108:109] op_sel:[0,0,1] op_sel_hi:[1,0,1]
    v_pk_fma_f32 v[84:85], v[84:85], v[108:109], v[108:109] op_sel:[0,0,1] op_sel_hi:[1,0,1]
    v_pk_fma_f32 v[86:87], v[86:87], v[108:109], v[108:109] op_sel:[0,0,1] op_sel_hi:[1,0,1]
    v_pk_mul_f32 v[80:81], v[80:81], v[16:17]
    v_pk_mul_f32 v[82:83], v[82:83], v[18:19]
    v_pk_mul_f32 v[84:85], v[84:85], v[20:21]
    v_pk_mul_f32 v[86:87], v[86:87], v[22:23]
    v_exp_f32 v80, v80
    v_exp_f32 v81, v81
    v_exp_f32 v82, v82
    v_exp_f32 v83, v83
    v_exp_f32 v84, v84
    v_exp_f32 v85, v85
    v_exp_f32 v86, v86
    v_exp_f32 v87, v87
    v_pk_fma_f32 v[80:81], v[80:81], v[110:111], v[110:111] op_sel_hi:[1,0,0]
    v_pk_fma_f32 v[82:83], v[82:83], v[110:111], v[110:111] op_sel_hi:[1,0,0]
    v_pk_fma_f32 v[84:85], v[84:85], v[110:111], v[110:111] op_sel_hi:[1,0,0]
    v_pk_fma_f32 v[86:87], v[86:87], v[110:111], v[110:111] op_sel_hi:[1,0,0]
    v_rcp_f32 v80, v80
    v_rcp_f32 v81, v81
    v_rcp_f32 v82, v82
    v_rcp_f32 v83, v83
    v_rcp_f32 v84, v84
    v_rcp_f32 v85, v85
    v_rcp_f32 v86, v86
    v_rcp_f32 v87, v87
    v_pk_mul_f32 v[80:81], v[80:81], v[16:17]
    v_pk_mul_f32 v[82:83], v[82:83], v[18:19]
    v_pk_mul_f32 v[84:85], v[84:85], v[20:21]
    v_pk_mul_f32 v[86:87], v[86:87], v[22:23]
    v_cvt_pk_bf16_f32 v32, v80, v81
    v_cvt_pk_bf16_f32 v33, v82, v83
    v_cvt_pk_bf16_f32 v34, v84, v85
    v_cvt_pk_bf16_f32 v35, v86, v87
    v_pk_mul_f32 v[88:89], v[24:25], v[24:25]
    v_pk_mul_f32 v[90:91], v[26:27], v[26:27]
    v_pk_mul_f32 v[92:93], v[28:29], v[28:29]
    v_pk_mul_f32 v[94:95], v[30:31], v[30:31]
    v_pk_fma_f32 v[88:89], v[88:89], v[112:113], v[112:113] op_sel:[0,0,1] op_sel_hi:[1,0,1]
    v_pk_fma_f32 v[90:91], v[90:91], v[112:113], v[112:113] op_sel:[0,0,1] op_sel_hi:[1,0,1]
    v_pk_fma_f32 v[92:93], v[92:93], v[112:113], v[112:113] op_sel:[0,0,1] op_sel_hi:[1,0,1]
    v_pk_fma_f32 v[94:95], v[94:95], v[112:113], v[112:113] op_sel:[0,0,1] op_sel_hi:[1,0,1]
    v_pk_mul_f32 v[88:89], v[88:89], v[24:25]
    v_pk_mul_f32 v[90:91], v[90:91], v[26:27]
    v_pk_mul_f32 v[92:93], v[92:93], v[28:29]
    v_pk_mul_f32 v[94:95], v[94:95], v[30:31]
    v_exp_f32 v88, v88
    v_exp_f32 v89, v89
    v_exp_f32 v90, v90
    v_exp_f32 v91, v91
    v_exp_f32 v92, v92
    v_exp_f32 v93, v93
    v_exp_f32 v94, v94
    v_exp_f32 v95, v95
    v_pk_fma_f32 v[88:89], v[88:89], v[114:115], v[114:115] op_sel_hi:[1,0,0]
    v_pk_fma_f32 v[90:91], v[90:91], v[114:115], v[114:115] op_sel_hi:[1,0,0]
    v_pk_fma_f32 v[92:93], v[92:93], v[114:115], v[114:115] op_sel_hi:[1,0,0]
    v_pk_fma_f32 v[94:95], v[94:95], v[114:115], v[114:115] op_sel_hi:[1,0,0]
    v_rcp_f32 v88, v88
    v_rcp_f32 v89, v89
    v_rcp_f32 v90, v90
    v_rcp_f32 v91, v91
    v_rcp_f32 v92, v92
    v_rcp_f32 v93, v93
    v_rcp_f32 v94, v94
    v_rcp_f32 v95, v95
    v_pk_mul_f32 v[88:89], v[88:89], v[24:25]
    v_pk_mul_f32 v[90:91], v[90:91], v[26:27]
    v_pk_mul_f32 v[92:93], v[92:93], v[28:29]
    v_pk_mul_f32 v[94:95], v[94:95], v[30:31]
    v_cvt_pk_bf16_f32 v36, v88, v89
    v_cvt_pk_bf16_f32 v37, v90, v91
    v_cvt_pk_bf16_f32 v38, v92, v93
    v_cvt_pk_bf16_f32 v39, v94, v95
    v_xor_b32 v119, 32, v117
    s_lshl_b32 s51, s33, 12
    s_cmp_le_i32 s24, 0
    s_cselect_b32 s60, 33, 32
    s_lshl_b32 s60, s60, 11
    s_cmp_le_i32 s24, 2
    s_cselect_b32 s61, 35, 34
    s_lshl_b32 s61, s61, 11
    s_cmp_le_i32 s24, 4
    s_cselect_b32 s62, 37, 36
    s_lshl_b32 s62, s62, 11
    s_cmp_le_i32 s24, 6
    s_cselect_b32 s63, 39, 38
    s_lshl_b32 s63, s63, 11
    s_cmp_le_i32 s24, 8
    s_cselect_b32 s64, 41, 40
    s_lshl_b32 s64, s64, 11
    s_barrier
    ds_read_b64_tr_b16 v[48:49], v117 offset:0
    ds_read_b64_tr_b16 v[50:51], v117 offset:256
    ds_read_b64_tr_b16 v[52:53], v119 offset:0
    ds_read_b64_tr_b16 v[54:55], v119 offset:256
    ds_read_b64_tr_b16 v[56:57], v117 offset:2048
    ds_read_b64_tr_b16 v[58:59], v117 offset:2304
    ds_read_b64_tr_b16 v[60:61], v119 offset:2048
    ds_read_b64_tr_b16 v[62:63], v119 offset:2304
    ds_read_b64_tr_b16 v[64:65], v117 offset:4096
    ds_read_b64_tr_b16 v[66:67], v117 offset:4352
    ds_read_b64_tr_b16 v[68:69], v119 offset:4096
    ds_read_b64_tr_b16 v[70:71], v119 offset:4352
    v_mfma_f32_16x16x32_bf16 v[16:19], v[72:75], v[96:99], 0
    v_mfma_f32_16x16x32_bf16 v[20:23], v[72:75], v[98:101], 0
    v_mfma_f32_16x16x32_bf16 v[24:27], v[72:75], v[100:103], 0
    v_mfma_f32_16x16x32_bf16 v[28:31], v[72:75], v[102:105], 0
    v_mov_b32 v72, v106
    s_waitcnt lgkmcnt(8)
    v_mfma_f32_16x16x32_bf16 v[16:19], v[48:51], v[128:131], v[16:19]
    v_mfma_f32_16x16x32_bf16 v[24:27], v[48:51], v[132:135], v[24:27]
    ds_read_b64_tr_b16 v[48:49], v117 offset:6144
    v_mfma_f32_16x16x32_bf16 v[28:31], v[52:55], v[132:135], v[28:31]
    ds_read_b64_tr_b16 v[50:51], v117 offset:6400
    v_mfma_f32_16x16x32_bf16 v[20:23], v[52:55], v[128:131], v[20:23]
    ds_read_b64_tr_b16 v[52:53], v119 offset:6144
    s_waitcnt lgkmcnt(7)
    v_mfma_f32_16x16x32_bf16 v[16:19], v[56:59], v[136:139], v[16:19]
    ds_read_b64_tr_b16 v[54:55], v119 offset:6400
    v_mfma_f32_16x16x32_bf16 v[24:27], v[56:59], v[140:143], v[24:27]
    ds_read_b64_tr_b16 v[56:57], v117 offset:8192
    v_mfma_f32_16x16x32_bf16 v[28:31], v[60:63], v[140:143], v[28:31]
    ds_read_b64_tr_b16 v[58:59], v117 offset:8448
    v_mfma_f32_16x16x32_bf16 v[20:23], v[60:63], v[136:139], v[20:23]
    ds_read_b64_tr_b16 v[60:61], v119 offset:8192
    s_waitcnt lgkmcnt(7)
    v_mfma_f32_16x16x32_bf16 v[16:19], v[64:67], v[144:147], v[16:19]
    ds_read_b64_tr_b16 v[62:63], v119 offset:8448
    v_mfma_f32_16x16x32_bf16 v[24:27], v[64:67], v[148:151], v[24:27]
    ds_read_b64_tr_b16 v[64:65], v117 offset:10240
    v_mfma_f32_16x16x32_bf16 v[28:31], v[68:71], v[148:151], v[28:31]
    ds_read_b64_tr_b16 v[66:67], v117 offset:10496
    v_mfma_f32_16x16x32_bf16 v[20:23], v[68:71], v[144:147], v[20:23]
    ds_read_b64_tr_b16 v[68:69], v119 offset:10240
    s_waitcnt lgkmcnt(7)
    v_mfma_f32_16x16x32_bf16 v[16:19], v[48:51], v[152:155], v[16:19]
    ds_read_b64_tr_b16 v[70:71], v119 offset:10496
    v_mfma_f32_16x16x32_bf16 v[24:27], v[48:51], v[156:159], v[24:27]
    ds_read_b64_tr_b16 v[48:49], v117 offset:12288
    v_mfma_f32_16x16x32_bf16 v[28:31], v[52:55], v[156:159], v[28:31]
    ds_read_b64_tr_b16 v[50:51], v117 offset:12544
    v_mfma_f32_16x16x32_bf16 v[20:23], v[52:55], v[152:155], v[20:23]
    ds_read_b64_tr_b16 v[52:53], v119 offset:12288
    s_waitcnt lgkmcnt(7)
    v_mfma_f32_16x16x32_bf16 v[16:19], v[56:59], v[160:163], v[16:19]
    ds_read_b64_tr_b16 v[54:55], v119 offset:12544
    v_mfma_f32_16x16x32_bf16 v[24:27], v[56:59], v[164:167], v[24:27]
    ds_read_b64_tr_b16 v[56:57], v117 offset:14336
    v_mfma_f32_16x16x32_bf16 v[28:31], v[60:63], v[164:167], v[28:31]
    ds_read_b64_tr_b16 v[58:59], v117 offset:14592
    v_mfma_f32_16x16x32_bf16 v[20:23], v[60:63], v[160:163], v[20:23]
    ds_read_b64_tr_b16 v[60:61], v119 offset:14336
    buffer_store_dwordx4 v[32:35], v2, s[40:43], s54 offen offset:0 sc1
    s_waitcnt lgkmcnt(7)
    v_mfma_f32_16x16x32_bf16 v[16:19], v[64:67], v[168:171], v[16:19]
    ds_read_b64_tr_b16 v[62:63], v119 offset:14592
    v_mfma_f32_16x16x32_bf16 v[24:27], v[64:67], v[172:175], v[24:27]
    ds_read_b64_tr_b16 v[64:65], v117 offset:16384
    v_mfma_f32_16x16x32_bf16 v[28:31], v[68:71], v[172:175], v[28:31]
    ds_read_b64_tr_b16 v[66:67], v117 offset:16640
    v_mfma_f32_16x16x32_bf16 v[20:23], v[68:71], v[168:171], v[20:23]
    ds_read_b64_tr_b16 v[68:69], v119 offset:16384
    s_waitcnt lgkmcnt(7)
    v_mfma_f32_16x16x32_bf16 v[16:19], v[48:51], v[176:179], v[16:19]
    ds_read_b64_tr_b16 v[70:71], v119 offset:16640
    v_mfma_f32_16x16x32_bf16 v[24:27], v[48:51], v[180:183], v[24:27]
    ds_read_b64_tr_b16 v[48:49], v117 offset:18432
    v_mfma_f32_16x16x32_bf16 v[28:31], v[52:55], v[180:183], v[28:31]
    ds_read_b64_tr_b16 v[50:51], v117 offset:18688
    v_mfma_f32_16x16x32_bf16 v[20:23], v[52:55], v[176:179], v[20:23]
    ds_read_b64_tr_b16 v[52:53], v119 offset:18432
    s_waitcnt lgkmcnt(7)
    v_mfma_f32_16x16x32_bf16 v[16:19], v[56:59], v[184:187], v[16:19]
    ds_read_b64_tr_b16 v[54:55], v119 offset:18688
    v_mfma_f32_16x16x32_bf16 v[24:27], v[56:59], v[188:191], v[24:27]
    ds_read_b64_tr_b16 v[56:57], v117 offset:20480
    v_mfma_f32_16x16x32_bf16 v[28:31], v[60:63], v[188:191], v[28:31]
    ds_read_b64_tr_b16 v[58:59], v117 offset:20736
    v_mfma_f32_16x16x32_bf16 v[20:23], v[60:63], v[184:187], v[20:23]
    ds_read_b64_tr_b16 v[60:61], v119 offset:20480
    s_waitcnt lgkmcnt(7)
    v_mfma_f32_16x16x32_bf16 v[16:19], v[64:67], v[192:195], v[16:19]
    ds_read_b64_tr_b16 v[62:63], v119 offset:20736
    v_mfma_f32_16x16x32_bf16 v[24:27], v[64:67], v[196:199], v[24:27]
    ds_read_b64_tr_b16 v[64:65], v117 offset:22528
    v_mfma_f32_16x16x32_bf16 v[28:31], v[68:71], v[196:199], v[28:31]
    ds_read_b64_tr_b16 v[66:67], v117 offset:22784
    v_mfma_f32_16x16x32_bf16 v[20:23], v[68:71], v[192:195], v[20:23]
    ds_read_b64_tr_b16 v[68:69], v119 offset:22528
    s_waitcnt lgkmcnt(7)
    v_mfma_f32_16x16x32_bf16 v[16:19], v[48:51], v[200:203], v[16:19]
    ds_read_b64_tr_b16 v[70:71], v119 offset:22784
    v_mfma_f32_16x16x32_bf16 v[24:27], v[48:51], v[204:207], v[24:27]
    ds_read_b64_tr_b16 v[48:49], v117 offset:24576
    v_mfma_f32_16x16x32_bf16 v[28:31], v[52:55], v[204:207], v[28:31]
    ds_read_b64_tr_b16 v[50:51], v117 offset:24832
    v_mfma_f32_16x16x32_bf16 v[20:23], v[52:55], v[200:203], v[20:23]
    ds_read_b64_tr_b16 v[52:53], v119 offset:24576
    s_waitcnt lgkmcnt(7)
    v_mfma_f32_16x16x32_bf16 v[16:19], v[56:59], v[208:211], v[16:19]
    ds_read_b64_tr_b16 v[54:55], v119 offset:24832
    v_mfma_f32_16x16x32_bf16 v[24:27], v[56:59], v[212:215], v[24:27]
    ds_read_b64_tr_b16 v[56:57], v117 offset:26624
    v_mfma_f32_16x16x32_bf16 v[28:31], v[60:63], v[212:215], v[28:31]
    ds_read_b64_tr_b16 v[58:59], v117 offset:26880
    v_mfma_f32_16x16x32_bf16 v[20:23], v[60:63], v[208:211], v[20:23]
    ds_read_b64_tr_b16 v[60:61], v119 offset:26624
    s_waitcnt lgkmcnt(7)
    v_mfma_f32_16x16x32_bf16 v[16:19], v[64:67], v[216:219], v[16:19]
    ds_read_b64_tr_b16 v[62:63], v119 offset:26880
    v_mfma_f32_16x16x32_bf16 v[24:27], v[64:67], v[220:223], v[24:27]
    ds_read_b64_tr_b16 v[64:65], v117 offset:28672
    v_mfma_f32_16x16x32_bf16 v[28:31], v[68:71], v[220:223], v[28:31]
    ds_read_b64_tr_b16 v[66:67], v117 offset:28928
    v_mfma_f32_16x16x32_bf16 v[20:23], v[68:71], v[216:219], v[20:23]
    ds_read_b64_tr_b16 v[68:69], v119 offset:28672
    s_waitcnt lgkmcnt(7)
    v_mfma_f32_16x16x32_bf16 v[16:19], v[48:51], v[224:227], v[16:19]
    ds_read_b64_tr_b16 v[70:71], v119 offset:28928
    v_mfma_f32_16x16x32_bf16 v[24:27], v[48:51], v[228:231], v[24:27]
    ds_read_b64_tr_b16 v[48:49], v117 offset:30720
    v_mfma_f32_16x16x32_bf16 v[28:31], v[52:55], v[228:231], v[28:31]
    ds_read_b64_tr_b16 v[50:51], v117 offset:30976
    v_mfma_f32_16x16x32_bf16 v[20:23], v[52:55], v[224:227], v[20:23]
    ds_read_b64_tr_b16 v[52:53], v119 offset:30720
    buffer_store_dwordx4 v[36:39], v2, s[40:43], s54 offen offset:1024 sc1
    s_waitcnt lgkmcnt(7)
    v_mfma_f32_16x16x32_bf16 v[16:19], v[56:59], v[232:235], v[16:19]
    ds_read_b64_tr_b16 v[54:55], v119 offset:30976
    v_mfma_f32_16x16x32_bf16 v[24:27], v[56:59], v[236:239], v[24:27]
    v_mfma_f32_16x16x32_bf16 v[28:31], v[60:63], v[236:239], v[28:31]
    v_mfma_f32_16x16x32_bf16 v[20:23], v[60:63], v[232:235], v[20:23]
    s_waitcnt lgkmcnt(4)
    v_mfma_f32_16x16x32_bf16 v[16:19], v[64:67], v[240:243], v[16:19]
    v_mfma_f32_16x16x32_bf16 v[24:27], v[64:67], v[244:247], v[24:27]
    v_mfma_f32_16x16x32_bf16 v[28:31], v[68:71], v[244:247], v[28:31]
    v_mfma_f32_16x16x32_bf16 v[20:23], v[68:71], v[240:243], v[20:23]
    s_waitcnt lgkmcnt(0)
    s_barrier
    v_mfma_f32_16x16x32_bf16 v[16:19], v[48:51], v[248:251], v[16:19]
    v_mfma_f32_16x16x32_bf16 v[24:27], v[48:51], v[252:255], v[24:27]
    v_mfma_f32_16x16x32_bf16 v[28:31], v[52:55], v[252:255], v[28:31]
    v_mfma_f32_16x16x32_bf16 v[20:23], v[52:55], v[248:251], v[20:23]
    s_nop 4
    v_pk_mul_f32 v[80:81], v[16:17], v[16:17]
    v_pk_mul_f32 v[82:83], v[18:19], v[18:19]
    s_nop 0
    v_pk_mul_f32 v[84:85], v[20:21], v[20:21]
    v_pk_mul_f32 v[86:87], v[22:23], v[22:23]
    v_pk_fma_f32 v[80:81], v[80:81], v[108:109], v[108:109] op_sel:[0,0,1] op_sel_hi:[1,0,1]
    v_pk_fma_f32 v[82:83], v[82:83], v[108:109], v[108:109] op_sel:[0,0,1] op_sel_hi:[1,0,1]
    v_pk_fma_f32 v[84:85], v[84:85], v[108:109], v[108:109] op_sel:[0,0,1] op_sel_hi:[1,0,1]
    v_pk_fma_f32 v[86:87], v[86:87], v[108:109], v[108:109] op_sel:[0,0,1] op_sel_hi:[1,0,1]
    v_pk_mul_f32 v[80:81], v[80:81], v[16:17]
    v_pk_mul_f32 v[82:83], v[82:83], v[18:19]
    v_pk_mul_f32 v[84:85], v[84:85], v[20:21]
    v_pk_mul_f32 v[86:87], v[86:87], v[22:23]
    v_exp_f32 v80, v80
    v_exp_f32 v81, v81
    v_exp_f32 v82, v82
    v_exp_f32 v83, v83
    v_exp_f32 v84, v84
    v_exp_f32 v85, v85
    v_exp_f32 v86, v86
    v_exp_f32 v87, v87
    v_pk_fma_f32 v[80:81], v[80:81], v[110:111], v[110:111] op_sel_hi:[1,0,0]
    v_pk_fma_f32 v[82:83], v[82:83], v[110:111], v[110:111] op_sel_hi:[1,0,0]
    v_pk_fma_f32 v[84:85], v[84:85], v[110:111], v[110:111] op_sel_hi:[1,0,0]
    v_pk_fma_f32 v[86:87], v[86:87], v[110:111], v[110:111] op_sel_hi:[1,0,0]
    v_rcp_f32 v80, v80
    v_rcp_f32 v81, v81
    v_rcp_f32 v82, v82
    v_rcp_f32 v83, v83
    v_rcp_f32 v84, v84
    v_rcp_f32 v85, v85
    v_rcp_f32 v86, v86
    v_rcp_f32 v87, v87
    v_pk_mul_f32 v[80:81], v[80:81], v[16:17]
    v_pk_mul_f32 v[82:83], v[82:83], v[18:19]
    v_pk_mul_f32 v[84:85], v[84:85], v[20:21]
    v_pk_mul_f32 v[86:87], v[86:87], v[22:23]
    v_cvt_pk_bf16_f32 v40, v80, v81
    v_cvt_pk_bf16_f32 v41, v82, v83
    v_cvt_pk_bf16_f32 v42, v84, v85
    v_cvt_pk_bf16_f32 v43, v86, v87
    v_pk_mul_f32 v[88:89], v[24:25], v[24:25]
    v_pk_mul_f32 v[90:91], v[26:27], v[26:27]
    v_pk_mul_f32 v[92:93], v[28:29], v[28:29]
    v_pk_mul_f32 v[94:95], v[30:31], v[30:31]
    v_pk_fma_f32 v[88:89], v[88:89], v[112:113], v[112:113] op_sel:[0,0,1] op_sel_hi:[1,0,1]
    v_pk_fma_f32 v[90:91], v[90:91], v[112:113], v[112:113] op_sel:[0,0,1] op_sel_hi:[1,0,1]
    v_pk_fma_f32 v[92:93], v[92:93], v[112:113], v[112:113] op_sel:[0,0,1] op_sel_hi:[1,0,1]
    v_pk_fma_f32 v[94:95], v[94:95], v[112:113], v[112:113] op_sel:[0,0,1] op_sel_hi:[1,0,1]
    v_pk_mul_f32 v[88:89], v[88:89], v[24:25]
    v_pk_mul_f32 v[90:91], v[90:91], v[26:27]
    v_pk_mul_f32 v[92:93], v[92:93], v[28:29]
    v_pk_mul_f32 v[94:95], v[94:95], v[30:31]
    v_exp_f32 v88, v88
    v_exp_f32 v89, v89
    v_exp_f32 v90, v90
    v_exp_f32 v91, v91
    v_exp_f32 v92, v92
    v_exp_f32 v93, v93
    v_exp_f32 v94, v94
    v_exp_f32 v95, v95
    v_pk_fma_f32 v[88:89], v[88:89], v[114:115], v[114:115] op_sel_hi:[1,0,0]
    v_pk_fma_f32 v[90:91], v[90:91], v[114:115], v[114:115] op_sel_hi:[1,0,0]
    v_pk_fma_f32 v[92:93], v[92:93], v[114:115], v[114:115] op_sel_hi:[1,0,0]
    v_pk_fma_f32 v[94:95], v[94:95], v[114:115], v[114:115] op_sel_hi:[1,0,0]
    v_rcp_f32 v88, v88
    v_rcp_f32 v89, v89
    v_rcp_f32 v90, v90
    v_rcp_f32 v91, v91
    v_rcp_f32 v92, v92
    v_rcp_f32 v93, v93
    v_rcp_f32 v94, v94
    v_rcp_f32 v95, v95
    v_pk_mul_f32 v[88:89], v[88:89], v[24:25]
    v_pk_mul_f32 v[90:91], v[90:91], v[26:27]
    v_pk_mul_f32 v[92:93], v[92:93], v[28:29]
    v_pk_mul_f32 v[94:95], v[94:95], v[30:31]
    v_cvt_pk_bf16_f32 v44, v88, v89
    v_cvt_pk_bf16_f32 v45, v90, v91
    v_cvt_pk_bf16_f32 v46, v92, v93
    v_cvt_pk_bf16_f32 v47, v94, v95
    v_xor_b32 v119, 32, v118
    s_barrier
    s_cmp_eq_u32 s56, 0x7f000000
    s_cbranch_scc1 L_skip2
    ds_read_b64_tr_b16 v[48:49], v118 offset:0
    ds_read_b64_tr_b16 v[50:51], v118 offset:256
    ds_read_b64_tr_b16 v[52:53], v119 offset:0
    ds_read_b64_tr_b16 v[54:55], v119 offset:256
    ds_read_b64_tr_b16 v[56:57], v118 offset:2048
    ds_read_b64_tr_b16 v[58:59], v118 offset:2304
    ds_read_b64_tr_b16 v[60:61], v119 offset:2048
    ds_read_b64_tr_b16 v[62:63], v119 offset:2304
    ds_read_b64_tr_b16 v[64:65], v118 offset:4096
    ds_read_b64_tr_b16 v[66:67], v118 offset:4352
    ds_read_b64_tr_b16 v[68:69], v119 offset:4096
    ds_read_b64_tr_b16 v[70:71], v119 offset:4352
    v_mfma_f32_16x16x32_bf16 v[16:19], v[72:75], v[96:99], 0
    v_mfma_f32_16x16x32_bf16 v[20:23], v[72:75], v[98:101], 0
    v_mfma_f32_16x16x32_bf16 v[24:27], v[72:75], v[100:103], 0
    v_mfma_f32_16x16x32_bf16 v[28:31], v[72:75], v[102:105], 0
    v_mov_b32 v72, v106
    s_waitcnt lgkmcnt(8)
    v_mfma_f32_16x16x32_bf16 v[16:19], v[48:51], v[128:131], v[16:19]
    v_mfma_f32_16x16x32_bf16 v[24:27], v[48:51], v[132:135], v[24:27]
    ds_read_b64_tr_b16 v[48:49], v118 offset:6144
    v_mfma_f32_16x16x32_bf16 v[28:31], v[52:55], v[132:135], v[28:31]
    ds_read_b64_tr_b16 v[50:51], v118 offset:6400
    v_mfma_f32_16x16x32_bf16 v[20:23], v[52:55], v[128:131], v[20:23]
    ds_read_b64_tr_b16 v[52:53], v119 offset:6144
    s_waitcnt lgkmcnt(7)
    v_mfma_f32_16x16x32_bf16 v[16:19], v[56:59], v[136:139], v[16:19]
    ds_read_b64_tr_b16 v[54:55], v119 offset:6400
    v_mfma_f32_16x16x32_bf16 v[24:27], v[56:59], v[140:143], v[24:27]
    ds_read_b64_tr_b16 v[56:57], v118 offset:8192
    v_mfma_f32_16x16x32_bf16 v[28:31], v[60:63], v[140:143], v[28:31]
    ds_read_b64_tr_b16 v[58:59], v118 offset:8448
    v_mfma_f32_16x16x32_bf16 v[20:23], v[60:63], v[136:139], v[20:23]
    ds_read_b64_tr_b16 v[60:61], v119 offset:8192
    s_waitcnt lgkmcnt(7)
    v_mfma_f32_16x16x32_bf16 v[16:19], v[64:67], v[144:147], v[16:19]
    ds_read_b64_tr_b16 v[62:63], v119 offset:8448
    v_mfma_f32_16x16x32_bf16 v[24:27], v[64:67], v[148:151], v[24:27]
    ds_read_b64_tr_b16 v[64:65], v118 offset:10240
    v_mfma_f32_16x16x32_bf16 v[28:31], v[68:71], v[148:151], v[28:31]
    ds_read_b64_tr_b16 v[66:67], v118 offset:10496
    v_mfma_f32_16x16x32_bf16 v[20:23], v[68:71], v[144:147], v[20:23]
    ds_read_b64_tr_b16 v[68:69], v119 offset:10240
    s_waitcnt lgkmcnt(7)
    v_mfma_f32_16x16x32_bf16 v[16:19], v[48:51], v[152:155], v[16:19]
    ds_read_b64_tr_b16 v[70:71], v119 offset:10496
    v_mfma_f32_16x16x32_bf16 v[24:27], v[48:51], v[156:159], v[24:27]
    ds_read_b64_tr_b16 v[48:49], v118 offset:12288
    v_mfma_f32_16x16x32_bf16 v[28:31], v[52:55], v[156:159], v[28:31]
    ds_read_b64_tr_b16 v[50:51], v118 offset:12544
    v_mfma_f32_16x16x32_bf16 v[20:23], v[52:55], v[152:155], v[20:23]
    ds_read_b64_tr_b16 v[52:53], v119 offset:12288
    s_waitcnt lgkmcnt(7)
    v_mfma_f32_16x16x32_bf16 v[16:19], v[56:59], v[160:163], v[16:19]
    ds_read_b64_tr_b16 v[54:55], v119 offset:12544
    v_mfma_f32_16x16x32_bf16 v[24:27], v[56:59], v[164:167], v[24:27]
    ds_read_b64_tr_b16 v[56:57], v118 offset:14336
    v_mfma_f32_16x16x32_bf16 v[28:31], v[60:63], v[164:167], v[28:31]
    ds_read_b64_tr_b16 v[58:59], v118 offset:14592
    v_mfma_f32_16x16x32_bf16 v[20:23], v[60:63], v[160:163], v[20:23]
    ds_read_b64_tr_b16 v[60:61], v119 offset:14336
    s_waitcnt lgkmcnt(7)
    v_mfma_f32_16x16x32_bf16 v[16:19], v[64:67], v[168:171], v[16:19]
    ds_read_b64_tr_b16 v[62:63], v119 offset:14592
    v_mfma_f32_16x16x32_bf16 v[24:27], v[64:67], v[172:175], v[24:27]
    ds_read_b64_tr_b16 v[64:65], v118 offset:16384
    v_mfma_f32_16x16x32_bf16 v[28:31], v[68:71], v[172:175], v[28:31]
    ds_read_b64_tr_b16 v[66:67], v118 offset:16640
    v_mfma_f32_16x16x32_bf16 v[20:23], v[68:71], v[168:171], v[20:23]
    ds_read_b64_tr_b16 v[68:69], v119 offset:16384
    s_waitcnt lgkmcnt(7)
    v_mfma_f32_16x16x32_bf16 v[16:19], v[48:51], v[176:179], v[16:19]
    ds_read_b64_tr_b16 v[70:71], v119 offset:16640
    v_mfma_f32_16x16x32_bf16 v[24:27], v[48:51], v[180:183], v[24:27]
    ds_read_b64_tr_b16 v[48:49], v118 offset:18432
    v_mfma_f32_16x16x32_bf16 v[28:31], v[52:55], v[180:183], v[28:31]
    ds_read_b64_tr_b16 v[50:51], v118 offset:18688
    v_mfma_f32_16x16x32_bf16 v[20:23], v[52:55], v[176:179], v[20:23]
    ds_read_b64_tr_b16 v[52:53], v119 offset:18432
    s_waitcnt lgkmcnt(7)
    v_mfma_f32_16x16x32_bf16 v[16:19], v[56:59], v[184:187], v[16:19]
    ds_read_b64_tr_b16 v[54:55], v119 offset:18688
    v_mfma_f32_16x16x32_bf16 v[24:27], v[56:59], v[188:191], v[24:27]
    ds_read_b64_tr_b16 v[56:57], v118 offset:20480
    v_mfma_f32_16x16x32_bf16 v[28:31], v[60:63], v[188:191], v[28:31]
    ds_read_b64_tr_b16 v[58:59], v118 offset:20736
    v_mfma_f32_16x16x32_bf16 v[20:23], v[60:63], v[184:187], v[20:23]
    ds_read_b64_tr_b16 v[60:61], v119 offset:20480
    s_waitcnt lgkmcnt(7)
    v_mfma_f32_16x16x32_bf16 v[16:19], v[64:67], v[192:195], v[16:19]
    ds_read_b64_tr_b16 v[62:63], v119 offset:20736
    v_mfma_f32_16x16x32_bf16 v[24:27], v[64:67], v[196:199], v[24:27]
    ds_read_b64_tr_b16 v[64:65], v118 offset:22528
    v_mfma_f32_16x16x32_bf16 v[28:31], v[68:71], v[196:199], v[28:31]
    ds_read_b64_tr_b16 v[66:67], v118 offset:22784
    v_mfma_f32_16x16x32_bf16 v[20:23], v[68:71], v[192:195], v[20:23]
    ds_read_b64_tr_b16 v[68:69], v119 offset:22528
    s_waitcnt lgkmcnt(7)
    v_mfma_f32_16x16x32_bf16 v[16:19], v[48:51], v[200:203], v[16:19]
    ds_read_b64_tr_b16 v[70:71], v119 offset:22784
    v_mfma_f32_16x16x32_bf16 v[24:27], v[48:51], v[204:207], v[24:27]
    ds_read_b64_tr_b16 v[48:49], v118 offset:24576
    v_mfma_f32_16x16x32_bf16 v[28:31], v[52:55], v[204:207], v[28:31]
    ds_read_b64_tr_b16 v[50:51], v118 offset:24832
    v_mfma_f32_16x16x32_bf16 v[20:23], v[52:55], v[200:203], v[20:23]
    ds_read_b64_tr_b16 v[52:53], v119 offset:24576
    s_waitcnt lgkmcnt(7)
    v_mfma_f32_16x16x32_bf16 v[16:19], v[56:59], v[208:211], v[16:19]
    ds_read_b64_tr_b16 v[54:55], v119 offset:24832
    v_mfma_f32_16x16x32_bf16 v[24:27], v[56:59], v[212:215], v[24:27]
    ds_read_b64_tr_b16 v[56:57], v118 offset:26624
    v_mfma_f32_16x16x32_bf16 v[28:31], v[60:63], v[212:215], v[28:31]
    ds_read_b64_tr_b16 v[58:59], v118 offset:26880
    v_mfma_f32_16x16x32_bf16 v[20:23], v[60:63], v[208:211], v[20:23]
    ds_read_b64_tr_b16 v[60:61], v119 offset:26624
    s_waitcnt lgkmcnt(7)
    v_mfma_f32_16x16x32_bf16 v[16:19], v[64:67], v[216:219], v[16:19]
    ds_read_b64_tr_b16 v[62:63], v119 offset:26880
    v_mfma_f32_16x16x32_bf16 v[24:27], v[64:67], v[220:223], v[24:27]
    ds_read_b64_tr_b16 v[64:65], v118 offset:28672
    v_mfma_f32_16x16x32_bf16 v[28:31], v[68:71], v[220:223], v[28:31]
    ds_read_b64_tr_b16 v[66:67], v118 offset:28928
    v_mfma_f32_16x16x32_bf16 v[20:23], v[68:71], v[216:219], v[20:23]
    ds_read_b64_tr_b16 v[68:69], v119 offset:28672
    s_waitcnt lgkmcnt(7)
    v_mfma_f32_16x16x32_bf16 v[16:19], v[48:51], v[224:227], v[16:19]
    ds_read_b64_tr_b16 v[70:71], v119 offset:28928
    v_mfma_f32_16x16x32_bf16 v[24:27], v[48:51], v[228:231], v[24:27]
    ds_read_b64_tr_b16 v[48:49], v118 offset:30720
    v_mfma_f32_16x16x32_bf16 v[28:31], v[52:55], v[228:231], v[28:31]
    ds_read_b64_tr_b16 v[50:51], v118 offset:30976
    v_mfma_f32_16x16x32_bf16 v[20:23], v[52:55], v[224:227], v[20:23]
    ds_read_b64_tr_b16 v[52:53], v119 offset:30720
    s_waitcnt lgkmcnt(7)
    v_mfma_f32_16x16x32_bf16 v[16:19], v[56:59], v[232:235], v[16:19]
    ds_read_b64_tr_b16 v[54:55], v119 offset:30976
    v_mfma_f32_16x16x32_bf16 v[24:27], v[56:59], v[236:239], v[24:27]
    v_mfma_f32_16x16x32_bf16 v[28:31], v[60:63], v[236:239], v[28:31]
    v_mfma_f32_16x16x32_bf16 v[20:23], v[60:63], v[232:235], v[20:23]
    s_waitcnt lgkmcnt(4)
    v_mfma_f32_16x16x32_bf16 v[16:19], v[64:67], v[240:243], v[16:19]
    v_mfma_f32_16x16x32_bf16 v[24:27], v[64:67], v[244:247], v[24:27]
    v_mfma_f32_16x16x32_bf16 v[28:31], v[68:71], v[244:247], v[28:31]
    v_mfma_f32_16x16x32_bf16 v[20:23], v[68:71], v[240:243], v[20:23]
    s_waitcnt lgkmcnt(0)
    s_barrier
    v_mfma_f32_16x16x32_bf16 v[16:19], v[48:51], v[248:251], v[16:19]
    v_mfma_f32_16x16x32_bf16 v[24:27], v[48:51], v[252:255], v[24:27]
    v_mfma_f32_16x16x32_bf16 v[28:31], v[52:55], v[252:255], v[28:31]
    v_mfma_f32_16x16x32_bf16 v[20:23], v[52:55], v[248:251], v[20:23]
    buffer_store_dwordx4 v[40:43], v2, s[40:43], s55 offen offset:0 sc1
    s_nop 3
    v_pk_mul_f32 v[80:81], v[16:17], v[16:17]
    v_pk_mul_f32 v[82:83], v[18:19], v[18:19]
    s_nop 0
    v_pk_mul_f32 v[84:85], v[20:21], v[20:21]
    v_pk_mul_f32 v[86:87], v[22:23], v[22:23]
    v_pk_fma_f32 v[80:81], v[80:81], v[108:109], v[108:109] op_sel:[0,0,1] op_sel_hi:[1,0,1]
    v_pk_fma_f32 v[82:83], v[82:83], v[108:109], v[108:109] op_sel:[0,0,1] op_sel_hi:[1,0,1]
    v_pk_fma_f32 v[84:85], v[84:85], v[108:109], v[108:109] op_sel:[0,0,1] op_sel_hi:[1,0,1]
    v_pk_fma_f32 v[86:87], v[86:87], v[108:109], v[108:109] op_sel:[0,0,1] op_sel_hi:[1,0,1]
    buffer_store_dwordx4 v[44:47], v2, s[40:43], s55 offen offset:1024 sc1
    v_pk_mul_f32 v[80:81], v[80:81], v[16:17]
    v_pk_mul_f32 v[82:83], v[82:83], v[18:19]
    v_pk_mul_f32 v[84:85], v[84:85], v[20:21]
    v_pk_mul_f32 v[86:87], v[86:87], v[22:23]
    v_exp_f32 v80, v80
    v_exp_f32 v81, v81
    v_exp_f32 v82, v82
    v_exp_f32 v83, v83
    v_exp_f32 v84, v84
    v_exp_f32 v85, v85
    v_exp_f32 v86, v86
    v_exp_f32 v87, v87
    v_pk_fma_f32 v[80:81], v[80:81], v[110:111], v[110:111] op_sel_hi:[1,0,0]
    v_pk_fma_f32 v[82:83], v[82:83], v[110:111], v[110:111] op_sel_hi:[1,0,0]
    v_pk_fma_f32 v[84:85], v[84:85], v[110:111], v[110:111] op_sel_hi:[1,0,0]
    v_pk_fma_f32 v[86:87], v[86:87], v[110:111], v[110:111] op_sel_hi:[1,0,0]
    v_rcp_f32 v80, v80
    v_rcp_f32 v81, v81
    v_rcp_f32 v82, v82
    v_rcp_f32 v83, v83
    v_rcp_f32 v84, v84
    v_rcp_f32 v85, v85
    v_rcp_f32 v86, v86
    v_rcp_f32 v87, v87
    v_pk_mul_f32 v[80:81], v[80:81], v[16:17]
    v_pk_mul_f32 v[82:83], v[82:83], v[18:19]
    v_pk_mul_f32 v[84:85], v[84:85], v[20:21]
    v_pk_mul_f32 v[86:87], v[86:87], v[22:23]
    v_cvt_pk_bf16_f32 v96, v80, v81
    v_cvt_pk_bf16_f32 v97, v82, v83
    v_cvt_pk_bf16_f32 v98, v84, v85
    v_cvt_pk_bf16_f32 v99, v86, v87
    buffer_store_dwordx4 v[96:99], v2, s[40:43], s56 offen offset:0 sc1
    v_pk_mul_f32 v[88:89], v[24:25], v[24:25]
    v_pk_mul_f32 v[90:91], v[26:27], v[26:27]
    v_pk_mul_f32 v[92:93], v[28:29], v[28:29]
    v_pk_mul_f32 v[94:95], v[30:31], v[30:31]
    v_pk_fma_f32 v[88:89], v[88:89], v[112:113], v[112:113] op_sel:[0,0,1] op_sel_hi:[1,0,1]
    v_pk_fma_f32 v[90:91], v[90:91], v[112:113], v[112:113] op_sel:[0,0,1] op_sel_hi:[1,0,1]
    v_pk_fma_f32 v[92:93], v[92:93], v[112:113], v[112:113] op_sel:[0,0,1] op_sel_hi:[1,0,1]
    v_pk_fma_f32 v[94:95], v[94:95], v[112:113], v[112:113] op_sel:[0,0,1] op_sel_hi:[1,0,1]
    v_pk_mul_f32 v[88:89], v[88:89], v[24:25]
    v_pk_mul_f32 v[90:91], v[90:91], v[26:27]
    v_pk_mul_f32 v[92:93], v[92:93], v[28:29]
    v_pk_mul_f32 v[94:95], v[94:95], v[30:31]
    v_exp_f32 v88, v88
    v_exp_f32 v89, v89
    v_exp_f32 v90, v90
    v_exp_f32 v91, v91
    v_exp_f32 v92, v92
    v_exp_f32 v93, v93
    v_exp_f32 v94, v94
    v_exp_f32 v95, v95
    v_pk_fma_f32 v[88:89], v[88:89], v[114:115], v[114:115] op_sel_hi:[1,0,0]
    v_pk_fma_f32 v[90:91], v[90:91], v[114:115], v[114:115] op_sel_hi:[1,0,0]
    v_pk_fma_f32 v[92:93], v[92:93], v[114:115], v[114:115] op_sel_hi:[1,0,0]
    v_pk_fma_f32 v[94:95], v[94:95], v[114:115], v[114:115] op_sel_hi:[1,0,0]
    v_rcp_f32 v88, v88
    v_rcp_f32 v89, v89
    v_rcp_f32 v90, v90
    v_rcp_f32 v91, v91
    v_rcp_f32 v92, v92
    v_rcp_f32 v93, v93
    v_rcp_f32 v94, v94
    v_rcp_f32 v95, v95
    v_pk_mul_f32 v[88:89], v[88:89], v[24:25]
    v_pk_mul_f32 v[90:91], v[90:91], v[26:27]
    v_pk_mul_f32 v[92:93], v[92:93], v[28:29]
    v_pk_mul_f32 v[94:95], v[94:95], v[30:31]
    v_cvt_pk_bf16_f32 v100, v88, v89
    v_cvt_pk_bf16_f32 v101, v90, v91
    v_cvt_pk_bf16_f32 v102, v92, v93
    v_cvt_pk_bf16_f32 v103, v94, v95
    buffer_store_dwordx4 v[100:103], v2, s[40:43], s56 offen offset:1024 sc1
L_skip2d:
    s_barrier
    s_setprio 3
    s_add_u32 m0, s69, 155648
    s_mul_i32 s68, s33, 43
    s_add_u32 s68, s68, 35
    s_lshr_b32 s68, s68, 3
    s_lshl_b32 s68, s68, 15
    buffer_load_dwordx4 v126, s[44:47], s68 offen lds
    s_add_u32 m0, s69, 98304
    s_xor_b32 s68, s33, 6
    s_mul_i32 s68, s68, 43
    s_add_u32 s68, s68, 3
    s_lshr_b32 s68, s68, 3
    s_lshl_b32 s68, s68, 15
    buffer_load_dwordx4 v126, s[44:47], s68 offen lds
    s_add_u32 m0, s69, 102400
    s_add_u32 s68, s68, 32768
    buffer_load_dwordx4 v126, s[44:47], s68 offen lds
    s_add_u32 m0, s69, 106496
    s_xor_b32 s68, s33, 7
    s_mul_i32 s68, s68, 43
    s_add_u32 s68, s68, 3
    s_lshr_b32 s68, s68, 3
    s_lshl_b32 s68, s68, 15
    buffer_load_dwordx4 v126, s[44:47], s68 offen lds
    ds_read_b64_tr_b16 v[48:49], v120 offset:0
    ds_read_b64_tr_b16 v[50:51], v120 offset:2048
    ds_read_b64_tr_b16 v[52:53], v121 offset:0
    ds_read_b64_tr_b16 v[54:55], v121 offset:2048
    s_add_u32 m0, s69, 110592
    s_add_u32 s68, s68, 32768
    buffer_load_dwordx4 v126, s[44:47], s68 offen lds
    ds_read_b64_tr_b16 v[56:57], v122 offset:0
    ds_read_b64_tr_b16 v[58:59], v122 offset:2048
    ds_read_b64_tr_b16 v[60:61], v123 offset:0
    ds_read_b64_tr_b16 v[62:63], v123 offset:2048
    s_add_u32 m0, s69, 114688
    s_xor_b32 s68, s33, 1
    s_mul_i32 s68, s68, 43
    s_add_u32 s68, s68, 19
    s_lshr_b32 s68, s68, 3
    s_lshl_b32 s68, s68, 15
    buffer_load_dwordx4 v126, s[44:47], s68 offen lds
    ds_read_b64_tr_b16 v[64:65], v120 offset:8192
    ds_read_b64_tr_b16 v[66:67], v120 offset:10240
    ds_read_b64_tr_b16 v[68:69], v121 offset:8192
    ds_read_b64_tr_b16 v[70:71], v121 offset:10240
    s_add_u32 m0, s69, 118784
    s_add_u32 s68, s68, 32768
    buffer_load_dwordx4 v126, s[44:47], s68 offen lds
    ds_read_b64_tr_b16 v[72:73], v122 offset:8192
    ds_read_b64_tr_b16 v[74:75], v122 offset:10240
    ds_read_b64_tr_b16 v[76:77], v123 offset:8192
    ds_read_b64_tr_b16 v[78:79], v123 offset:10240
    s_add_u32 m0, s69, 122880
    s_xor_b32 s68, s33, 2
    s_mul_i32 s68, s68, 43
    s_add_u32 s68, s68, 19
    s_lshr_b32 s68, s68, 3
    s_lshl_b32 s68, s68, 15
    buffer_load_dwordx4 v126, s[44:47], s68 offen lds
    ds_read_b64_tr_b16 v[128:129], v120 offset:16384
    ds_read_b64_tr_b16 v[130:131], v120 offset:18432
    ds_read_b64_tr_b16 v[132:133], v121 offset:16384
    ds_read_b64_tr_b16 v[134:135], v121 offset:18432
    s_add_u32 m0, s69, 126976
    s_add_u32 s68, s68, 32768
    buffer_load_dwordx4 v126, s[44:47], s68 offen lds
    ds_read_b64_tr_b16 v[136:137], v122 offset:16384
    ds_read_b64_tr_b16 v[138:139], v122 offset:18432
    ds_read_b64_tr_b16 v[140:141], v123 offset:16384
    ds_read_b64_tr_b16 v[142:143], v123 offset:18432
    s_waitcnt vmcnt(9)
    s_add_u32 m0, s69, 32768
    s_xor_b32 s68, s33, 3
    s_mul_i32 s68, s68, 43
    s_add_u32 s68, s68, 19
    s_lshr_b32 s68, s68, 3
    s_lshl_b32 s68, s68, 15
    buffer_load_dwordx4 v126, s[44:47], s68 offen lds
    ds_read_b64_tr_b16 v[144:145], v120 offset:24576
    ds_read_b64_tr_b16 v[146:147], v120 offset:26624
    ds_read_b64_tr_b16 v[148:149], v121 offset:24576
    ds_read_b64_tr_b16 v[150:151], v121 offset:26624
    s_mov_b64 exec, 1
    buffer_store_dword v6, off, s[40:43], s26 offset:0 sc1
    s_mov_b64 exec, -1
    s_waitcnt vmcnt(9)
    s_add_u32 m0, s69, 36864
    s_add_u32 s68, s68, 32768
    buffer_load_dwordx4 v126, s[44:47], s68 offen lds
    ds_read_b64_tr_b16 v[152:153], v122 offset:24576
    ds_read_b64_tr_b16 v[154:155], v122 offset:26624
    ds_read_b64_tr_b16 v[156:157], v123 offset:24576
    ds_read_b64_tr_b16 v[158:159], v123 offset:26624
    s_waitcnt vmcnt(9)
    s_add_u32 m0, s69, 40960
    s_xor_b32 s68, s33, 4
    s_mul_i32 s68, s68, 43
    s_add_u32 s68, s68, 19
    s_lshr_b32 s68, s68, 3
    s_lshl_b32 s68, s68, 15
    buffer_load_dwordx4 v126, s[44:47], s68 offen lds
    v_add_u32 v120, 0x20000, v120
    v_add_u32 v121, 0x20000, v121
    ds_read_b64_tr_b16 v[160:161], v120 offset:8192
    ds_read_b64_tr_b16 v[162:163], v120 offset:10240
    ds_read_b64_tr_b16 v[164:165], v121 offset:8192
    ds_read_b64_tr_b16 v[166:167], v121 offset:10240
    s_waitcnt vmcnt(9)
    s_add_u32 m0, s69, 45056
    s_add_u32 s68, s68, 32768
    buffer_load_dwordx4 v126, s[44:47], s68 offen lds
    v_add_u32 v122, 0x20000, v122
    v_add_u32 v123, 0x20000, v123
    ds_read_b64_tr_b16 v[168:169], v122 offset:8192
    ds_read_b64_tr_b16 v[170:171], v122 offset:10240
    ds_read_b64_tr_b16 v[172:173], v123 offset:8192
    ds_read_b64_tr_b16 v[174:175], v123 offset:10240
    s_waitcnt vmcnt(9)
    s_add_u32 m0, s69, 49152
    s_xor_b32 s68, s33, 5
    s_mul_i32 s68, s68, 43
    s_add_u32 s68, s68, 19
    s_lshr_b32 s68, s68, 3
    s_lshl_b32 s68, s68, 15
    buffer_load_dwordx4 v126, s[44:47], s68 offen lds
    ds_read_b64_tr_b16 v[176:177], v120 offset:16384
    ds_read_b64_tr_b16 v[178:179], v120 offset:18432
    ds_read_b64_tr_b16 v[180:181], v121 offset:16384
    ds_read_b64_tr_b16 v[182:183], v121 offset:18432
    s_waitcnt vmcnt(9)
    s_add_u32 m0, s69, 53248
    s_add_u32 s68, s68, 32768
    buffer_load_dwordx4 v126, s[44:47], s68 offen lds
    ds_read_b64_tr_b16 v[184:185], v122 offset:16384
    ds_read_b64_tr_b16 v[186:187], v122 offset:18432
    ds_read_b64_tr_b16 v[188:189], v123 offset:16384
    ds_read_b64_tr_b16 v[190:191], v123 offset:18432
    s_mov_b64 exec, 1
    ds_add_u32 v127, v1 offset:16
    s_mov_b64 exec, -1
    s_setprio 3
    s_waitcnt vmcnt(9)
    s_add_u32 m0, s69, 57344
    s_xor_b32 s68, s33, 6
    s_mul_i32 s68, s68, 43
    s_add_u32 s68, s68, 19
    s_lshr_b32 s68, s68, 3
    s_lshl_b32 s68, s68, 15
    buffer_load_dwordx4 v126, s[44:47], s68 offen lds
    s_waitcnt vmcnt(9)
    s_add_u32 m0, s69, 61440
    s_add_u32 s68, s68, 32768
    buffer_load_dwordx4 v126, s[44:47], s68 offen lds
    ds_read_b32 v8, v127 offset:16
    s_waitcnt lgkmcnt(0)
    v_cmp_gt_u32 vcc, 4, v8
    s_nop 1
    s_cbranch_vccnz L_spS0
L_spdS0:
    s_waitcnt vmcnt(9)
    s_add_u32 m0, s69, 0
    s_xor_b32 s68, s33, 7
    s_mul_i32 s68, s68, 43
    s_add_u32 s68, s68, 19
    s_lshr_b32 s68, s68, 3
    s_lshl_b32 s68, s68, 15
    buffer_load_dwordx4 v126, s[44:47], s68 offen lds
    s_waitcnt vmcnt(9)
    s_add_u32 m0, s69, 4096
    s_add_u32 s68, s68, 32768
    buffer_load_dwordx4 v126, s[44:47], s68 offen lds
    s_waitcnt vmcnt(9)
    s_add_u32 m0, s69, 8192
    s_cmp_le_u32 s25, 0
    s_cselect_b32 s68, 9, 4
    s_lshl_b32 s68, s68, 15
    buffer_load_dwordx4 v126, s[44:47], s68 offen lds
    s_waitcnt vmcnt(9)
    s_add_u32 m0, s69, 12288
    s_cmp_le_u32 s25, 1
    s_cselect_b32 s68, 10, 9
    s_lshl_b32 s68, s68, 15
    buffer_load_dwordx4 v126, s[44:47], s68 offen lds
    s_waitcnt vmcnt(9)
    s_add_u32 m0, s69, 16384
    s_cmp_le_u32 s25, 2
    s_cselect_b32 s68, 15, 10
    s_lshl_b32 s68, s68, 15
    buffer_load_dwordx4 v126, s[44:47], s68 offen lds
    s_waitcnt vmcnt(9)
    s_add_u32 m0, s69, 20480
    s_cmp_le_u32 s25, 3
    s_cselect_b32 s68, 20, 15
    s_lshl_b32 s68, s68, 15
    buffer_load_dwordx4 v126, s[44:47], s68 offen lds
    s_waitcnt vmcnt(9)
    s_add_u32 m0, s69, 24576
    s_cmp_le_u32 s25, 4
    s_cselect_b32 s68, 25, 20
    s_lshl_b32 s68, s68, 15
    buffer_load_dwordx4 v126, s[44:47], s68 offen lds
    s_waitcnt vmcnt(9)
    s_add_u32 m0, s69, 28672
    s_cmp_le_u32 s25, 5
    s_cselect_b32 s68, 26, 25
    s_lshl_b32 s68, s68, 15
    buffer_load_dwordx4 v126, s[44:47], s68 offen lds
    s_load_dwordx16 s[4:19], s[30:31], s70 glc
    s_waitcnt vmcnt(9)
    s_add_u32 m0, s69, 139264
    s_cmp_le_u32 s25, 6
    s_cselect_b32 s68, 31, 26
    s_lshl_b32 s68, s68, 15
    buffer_load_dwordx4 v126, s[44:47], s68 offen lds
    s_waitcnt vmcnt(9)
    s_add_u32 m0, s69, 143360
    s_cmp_le_u32 s25, 7
    s_cselect_b32 s68, 36, 31
    s_lshl_b32 s68, s68, 15
    buffer_load_dwordx4 v126, s[44:47], s68 offen lds
    s_waitcnt vmcnt(9)
    s_add_u32 m0, s69, 147456
    s_cmp_le_u32 s25, 8
    s_cselect_b32 s68, 37, 36
    s_lshl_b32 s68, s68, 15
    buffer_load_dwordx4 v126, s[44:47], s68 offen lds
    s_waitcnt vmcnt(9)
    s_add_u32 m0, s69, 151552
    s_cmp_le_u32 s25, 9
    s_cselect_b32 s68, 42, 37
    s_lshl_b32 s68, s68, 15
    buffer_load_dwordx4 v126, s[44:47], s68 offen lds
    s_waitcnt lgkmcnt(0)
    s_xor_b64 s[4:5], s[4:5], s[28:29]
    s_xor_b64 s[6:7], s[6:7], s[28:29]
    s_xor_b64 s[8:9], s[8:9], s[28:29]
    s_xor_b64 s[10:11], s[10:11], s[28:29]
    s_xor_b64 s[12:13], s[12:13], s[28:29]
    s_xor_b64 s[14:15], s[14:15], s[28:29]
    s_xor_b64 s[16:17], s[16:17], s[28:29]
    s_xor_b64 s[18:19], s[18:19], s[28:29]
    s_or_b64 s[4:5], s[4:5], s[6:7]
    s_or_b64 s[4:5], s[4:5], s[8:9]
    s_or_b64 s[4:5], s[4:5], s[10:11]
    s_or_b64 s[4:5], s[4:5], s[12:13]
    s_or_b64 s[4:5], s[4:5], s[14:15]
    s_or_b64 s[4:5], s[4:5], s[16:17]
    s_or_b64 s[4:5], s[4:5], s[18:19]
    s_cbranch_scc1 L_gpA1
L_gpdA1:
    s_waitcnt vmcnt(9)
    s_xor_b32 s52, s51, 4096
    buffer_load_dwordx4 v[192:195], v3, s[40:43], s52 offen offset:0 sc1
    s_waitcnt vmcnt(9)
    buffer_load_dwordx4 v[196:199], v3, s[40:43], s52 offen offset:1024 sc1
    s_waitcnt vmcnt(9)
    s_xor_b32 s52, s51, 8192
    buffer_load_dwordx4 v[200:203], v3, s[40:43], s52 offen offset:0 sc1
    s_waitcnt vmcnt(9)
    buffer_load_dwordx4 v[204:207], v3, s[40:43], s52 offen offset:1024 sc1
    s_waitcnt vmcnt(9)
    s_xor_b32 s52, s51, 12288
    buffer_load_dwordx4 v[208:211], v3, s[40:43], s52 offen offset:0 sc1
    s_waitcnt vmcnt(9)
    buffer_load_dwordx4 v[212:215], v3, s[40:43], s52 offen offset:1024 sc1
    s_waitcnt vmcnt(9)
    s_xor_b32 s52, s51, 16384
    buffer_load_dwordx4 v[216:219], v3, s[40:43], s52 offen offset:0 sc1
    s_waitcnt vmcnt(9)
    buffer_load_dwordx4 v[220:223], v3, s[40:43], s52 offen offset:1024 sc1
    s_setprio 0
    v_mfma_f32_16x16x32_bf16 v[16:19], v[48:51], v[32:35], 0
    v_mfma_f32_16x16x32_bf16 v[20:23], v[48:51], v[36:39], 0
    v_mfma_f32_16x16x32_bf16 v[28:31], v[52:55], v[36:39], 0
    v_mfma_f32_16x16x32_bf16 v[24:27], v[52:55], v[32:35], 0
    s_xor_b32 s52, s51, 20480
    buffer_load_dwordx4 v[224:227], v3, s[40:43], s52 offen offset:0 sc1
    v_mfma_f32_16x16x32_bf16 v[80:83], v[56:59], v[32:35], 0
    v_mfma_f32_16x16x32_bf16 v[84:87], v[56:59], v[36:39], 0
    v_mfma_f32_16x16x32_bf16 v[92:95], v[60:63], v[36:39], 0
    v_mfma_f32_16x16x32_bf16 v[88:91], v[60:63], v[32:35], 0
    buffer_load_dwordx4 v[228:231], v3, s[40:43], s52 offen offset:1024 sc1
    v_mfma_f32_16x16x32_bf16 v[16:19], v[64:67], v[40:43], v[16:19]
    v_mfma_f32_16x16x32_bf16 v[20:23], v[64:67], v[44:47], v[20:23]
    v_mfma_f32_16x16x32_bf16 v[28:31], v[68:71], v[44:47], v[28:31]
    v_mfma_f32_16x16x32_bf16 v[24:27], v[68:71], v[40:43], v[24:27]
    s_waitcnt vmcnt(10)
    s_mov_b64 exec, 1
    ds_add_u32 v127, v1 offset:8
    s_mov_b64 exec, -1
    s_xor_b32 s52, s51, 24576
    buffer_load_dwordx4 v[232:235], v3, s[40:43], s52 offen offset:0 sc1
    v_mfma_f32_16x16x32_bf16 v[80:83], v[72:75], v[40:43], v[80:83]
    v_mfma_f32_16x16x32_bf16 v[84:87], v[72:75], v[44:47], v[84:87]
    v_mfma_f32_16x16x32_bf16 v[92:95], v[76:79], v[44:47], v[92:95]
    v_mfma_f32_16x16x32_bf16 v[88:91], v[76:79], v[40:43], v[88:91]
    buffer_load_dwordx4 v[236:239], v3, s[40:43], s52 offen offset:1024 sc1
    s_waitcnt vmcnt(10)
    v_mfma_f32_16x16x32_bf16 v[16:19], v[128:131], v[192:195], v[16:19]
    v_mfma_f32_16x16x32_bf16 v[20:23], v[128:131], v[196:199], v[20:23]
    v_mfma_f32_16x16x32_bf16 v[28:31], v[132:135], v[196:199], v[28:31]
    v_mfma_f32_16x16x32_bf16 v[24:27], v[132:135], v[192:195], v[24:27]
    s_xor_b32 s52, s51, 28672
    buffer_load_dwordx4 v[240:243], v3, s[40:43], s52 offen offset:0 sc1
    v_mfma_f32_16x16x32_bf16 v[80:83], v[136:139], v[192:195], v[80:83]
    v_mfma_f32_16x16x32_bf16 v[84:87], v[136:139], v[196:199], v[84:87]
    v_mfma_f32_16x16x32_bf16 v[92:95], v[140:143], v[196:199], v[92:95]
    v_mfma_f32_16x16x32_bf16 v[88:91], v[140:143], v[192:195], v[88:91]
    buffer_load_dwordx4 v[244:247], v3, s[40:43], s52 offen offset:1024 sc1
    s_waitcnt vmcnt(10)
    v_mfma_f32_16x16x32_bf16 v[16:19], v[144:147], v[200:203], v[16:19]
    v_mfma_f32_16x16x32_bf16 v[20:23], v[144:147], v[204:207], v[20:23]
    v_mfma_f32_16x16x32_bf16 v[28:31], v[148:151], v[204:207], v[28:31]
    v_mfma_f32_16x16x32_bf16 v[24:27], v[148:151], v[200:203], v[24:27]
    s_xor_b32 s52, s51, 36864
    buffer_load_dwordx4 v[248:251], v3, s[40:43], s52 offen offset:0 sc1
    v_mfma_f32_16x16x32_bf16 v[80:83], v[152:155], v[200:203], v[80:83]
    v_mfma_f32_16x16x32_bf16 v[84:87], v[152:155], v[204:207], v[84:87]
    v_mfma_f32_16x16x32_bf16 v[92:95], v[156:159], v[204:207], v[92:95]
    v_mfma_f32_16x16x32_bf16 v[88:91], v[156:159], v[200:203], v[88:91]
    buffer_load_dwordx4 v[252:255], v3, s[40:43], s52 offen offset:1024 sc1
    s_waitcnt vmcnt(10)
    v_mfma_f32_16x16x32_bf16 v[16:19], v[160:163], v[208:211], v[16:19]
    v_mfma_f32_16x16x32_bf16 v[20:23], v[160:163], v[212:215], v[20:23]
    v_mfma_f32_16x16x32_bf16 v[28:31], v[164:167], v[212:215], v[28:31]
    v_mfma_f32_16x16x32_bf16 v[24:27], v[164:167], v[208:211], v[24:27]
    s_xor_b32 s52, s51, 40960
    buffer_load_dwordx4 v[32:35], v3, s[40:43], s52 offen offset:0 sc1
    v_mfma_f32_16x16x32_bf16 v[80:83], v[168:171], v[208:211], v[80:83]
    ds_read_b64_tr_b16 v[48:49], v120 offset:0
    v_mfma_f32_16x16x32_bf16 v[84:87], v[168:171], v[212:215], v[84:87]
    ds_read_b64_tr_b16 v[50:51], v120 offset:2048
    v_mfma_f32_16x16x32_bf16 v[92:95], v[172:175], v[212:215], v[92:95]
    ds_read_b64_tr_b16 v[52:53], v121 offset:0
    v_mfma_f32_16x16x32_bf16 v[88:91], v[172:175], v[208:211], v[88:91]
    ds_read_b64_tr_b16 v[54:55], v121 offset:2048
    ds_read_b32 v8, v127 offset:8
    buffer_load_dwordx4 v[36:39], v3, s[40:43], s52 offen offset:1024 sc1
    s_waitcnt vmcnt(10)
    v_mfma_f32_16x16x32_bf16 v[16:19], v[176:179], v[216:219], v[16:19]
    ds_read_b64_tr_b16 v[56:57], v122 offset:0
    v_mfma_f32_16x16x32_bf16 v[20:23], v[176:179], v[220:223], v[20:23]
    ds_read_b64_tr_b16 v[58:59], v122 offset:2048
    v_mfma_f32_16x16x32_bf16 v[28:31], v[180:183], v[220:223], v[28:31]
    ds_read_b64_tr_b16 v[60:61], v123 offset:0
    v_mfma_f32_16x16x32_bf16 v[24:27], v[180:183], v[216:219], v[24:27]
    ds_read_b64_tr_b16 v[62:63], v123 offset:2048
    s_waitcnt lgkmcnt(4)
    v_cmp_gt_u32 vcc, 4, v8
    s_nop 1
    s_cbranch_vccnz L_spW2A
L_spdW2A:
    s_cmp_lg_u32 s67, 0
    s_cbranch_scc1 L_noown
    ds_read_b64_tr_b16 v[128:129], v120 offset:24576
    ds_read_b64_tr_b16 v[130:131], v120 offset:26624
    ds_read_b64_tr_b16 v[132:133], v121 offset:24576
    ds_read_b64_tr_b16 v[134:135], v121 offset:26624
    ds_read_b64_tr_b16 v[136:137], v122 offset:24576
    ds_read_b64_tr_b16 v[138:139], v122 offset:26624
    ds_read_b64_tr_b16 v[140:141], v123 offset:24576
    ds_read_b64_tr_b16 v[142:143], v123 offset:26624
    s_waitcnt lgkmcnt(4)
    v_mfma_f32_16x16x32_bf16 v[16:19], v[128:131], v[96:99], v[16:19]
    v_mfma_f32_16x16x32_bf16 v[20:23], v[128:131], v[100:103], v[20:23]
    v_mfma_f32_16x16x32_bf16 v[28:31], v[132:135], v[100:103], v[28:31]
    v_mfma_f32_16x16x32_bf16 v[24:27], v[132:135], v[96:99], v[24:27]
    s_waitcnt lgkmcnt(0)
    v_mfma_f32_16x16x32_bf16 v[80:83], v[136:139], v[96:99], v[80:83]
    v_mfma_f32_16x16x32_bf16 v[84:87], v[136:139], v[100:103], v[84:87]
    v_mfma_f32_16x16x32_bf16 v[92:95], v[140:143], v[100:103], v[92:95]
    v_mfma_f32_16x16x32_bf16 v[88:91], v[140:143], v[96:99], v[88:91]
L_noown:
    s_xor_b32 s52, s51, 45056
    buffer_load_dwordx4 v[40:43], v3, s[40:43], s52 offen offset:0 sc1
    v_mfma_f32_16x16x32_bf16 v[80:83], v[184:187], v[216:219], v[80:83]
    v_add_u32 v120, 0xffff0000, v120
    v_add_u32 v121, 0xffff0000, v121
    ds_read_b64_tr_b16 v[64:65], v120 offset:32768
    v_mfma_f32_16x16x32_bf16 v[84:87], v[184:187], v[220:223], v[84:87]
    ds_read_b64_tr_b16 v[66:67], v120 offset:34816
    v_mfma_f32_16x16x32_bf16 v[92:95], v[188:191], v[220:223], v[92:95]
    ds_read_b64_tr_b16 v[68:69], v121 offset:32768
    v_mfma_f32_16x16x32_bf16 v[88:91], v[188:191], v[216:219], v[88:91]
    ds_read_b64_tr_b16 v[70:71], v121 offset:34816
    buffer_load_dwordx4 v[44:47], v3, s[40:43], s52 offen offset:1024 sc1
    s_waitcnt vmcnt(10)
    v_mfma_f32_16x16x32_bf16 v[16:19], v[48:51], v[224:227], v[16:19]
    v_add_u32 v122, 0xffff0000, v122
    v_add_u32 v123, 0xffff0000, v123
    ds_read_b64_tr_b16 v[72:73], v122 offset:32768
    v_mfma_f32_16x16x32_bf16 v[20:23], v[48:51], v[228:231], v[20:23]
    ds_read_b64_tr_b16 v[74:75], v122 offset:34816
    v_mfma_f32_16x16x32_bf16 v[28:31], v[52:55], v[228:231], v[28:31]
    ds_read_b64_tr_b16 v[76:77], v123 offset:32768
    v_mfma_f32_16x16x32_bf16 v[24:27], v[52:55], v[224:227], v[24:27]
    ds_read_b64_tr_b16 v[78:79], v123 offset:34816
    s_xor_b32 s52, s51, 49152
    buffer_load_dwordx4 v[192:195], v3, s[40:43], s52 offen offset:0 sc1
    s_waitcnt lgkmcnt(8)
    v_mfma_f32_16x16x32_bf16 v[80:83], v[56:59], v[224:227], v[80:83]
    ds_read_b64_tr_b16 v[48:49], v120 offset:40960
    v_mfma_f32_16x16x32_bf16 v[84:87], v[56:59], v[228:231], v[84:87]
    ds_read_b64_tr_b16 v[50:51], v120 offset:43008
    v_mfma_f32_16x16x32_bf16 v[92:95], v[60:63], v[228:231], v[92:95]
    ds_read_b64_tr_b16 v[52:53], v121 offset:40960
    v_mfma_f32_16x16x32_bf16 v[88:91], v[60:63], v[224:227], v[88:91]
    ds_read_b64_tr_b16 v[54:55], v121 offset:43008
    buffer_load_dwordx4 v[196:199], v3, s[40:43], s52 offen offset:1024 sc1
    s_waitcnt vmcnt(10) lgkmcnt(8)
    v_mfma_f32_16x16x32_bf16 v[16:19], v[64:67], v[232:235], v[16:19]
    ds_read_b64_tr_b16 v[56:57], v122 offset:40960
    v_mfma_f32_16x16x32_bf16 v[20:23], v[64:67], v[236:239], v[20:23]
    ds_read_b64_tr_b16 v[58:59], v122 offset:43008
    v_mfma_f32_16x16x32_bf16 v[28:31], v[68:71], v[236:239], v[28:31]
    ds_read_b64_tr_b16 v[60:61], v123 offset:40960
    v_mfma_f32_16x16x32_bf16 v[24:27], v[68:71], v[232:235], v[24:27]
    ds_read_b64_tr_b16 v[62:63], v123 offset:43008
    s_xor_b32 s52, s51, 53248
    buffer_load_dwordx4 v[200:203], v3, s[40:43], s52 offen offset:0 sc1
    s_waitcnt lgkmcnt(8)
    v_mfma_f32_16x16x32_bf16 v[80:83], v[72:75], v[232:235], v[80:83]
    ds_read_b64_tr_b16 v[64:65], v120 offset:49152
    v_mfma_f32_16x16x32_bf16 v[84:87], v[72:75], v[236:239], v[84:87]
    ds_read_b64_tr_b16 v[66:67], v120 offset:51200
    v_mfma_f32_16x16x32_bf16 v[92:95], v[76:79], v[236:239], v[92:95]
    ds_read_b64_tr_b16 v[68:69], v121 offset:49152
    v_mfma_f32_16x16x32_bf16 v[88:91], v[76:79], v[232:235], v[88:91]
    ds_read_b64_tr_b16 v[70:71], v121 offset:51200
    buffer_load_dwordx4 v[204:207], v3, s[40:43], s52 offen offset:1024 sc1
    s_waitcnt vmcnt(10) lgkmcnt(8)
    v_mfma_f32_16x16x32_bf16 v[16:19], v[48:51], v[240:243], v[16:19]
    ds_read_b64_tr_b16 v[72:73], v122 offset:49152
    v_mfma_f32_16x16x32_bf16 v[20:23], v[48:51], v[244:247], v[20:23]
    ds_read_b64_tr_b16 v[74:75], v122 offset:51200
    v_mfma_f32_16x16x32_bf16 v[28:31], v[52:55], v[244:247], v[28:31]
    ds_read_b64_tr_b16 v[76:77], v123 offset:49152
    v_mfma_f32_16x16x32_bf16 v[24:27], v[52:55], v[240:243], v[24:27]
    ds_read_b64_tr_b16 v[78:79], v123 offset:51200
    s_xor_b32 s52, s51, 57344
    buffer_load_dwordx4 v[208:211], v3, s[40:43], s52 offen offset:0 sc1
    s_waitcnt lgkmcnt(8)
    v_mfma_f32_16x16x32_bf16 v[80:83], v[56:59], v[240:243], v[80:83]
    ds_read_b64_tr_b16 v[48:49], v120 offset:57344
    v_mfma_f32_16x16x32_bf16 v[84:87], v[56:59], v[244:247], v[84:87]
    ds_read_b64_tr_b16 v[50:51], v120 offset:59392
    v_mfma_f32_16x16x32_bf16 v[92:95], v[60:63], v[244:247], v[92:95]
    ds_read_b64_tr_b16 v[52:53], v121 offset:57344
    v_mfma_f32_16x16x32_bf16 v[88:91], v[60:63], v[240:243], v[88:91]
    ds_read_b64_tr_b16 v[54:55], v121 offset:59392
    buffer_load_dwordx4 v[212:215], v3, s[40:43], s52 offen offset:1024 sc1
    s_waitcnt vmcnt(10) lgkmcnt(8)
    v_mfma_f32_16x16x32_bf16 v[16:19], v[64:67], v[248:251], v[16:19]
    ds_read_b64_tr_b16 v[56:57], v122 offset:57344
    v_mfma_f32_16x16x32_bf16 v[20:23], v[64:67], v[252:255], v[20:23]
    ds_read_b64_tr_b16 v[58:59], v122 offset:59392
    v_mfma_f32_16x16x32_bf16 v[28:31], v[68:71], v[252:255], v[28:31]
    ds_read_b64_tr_b16 v[60:61], v123 offset:57344
    v_mfma_f32_16x16x32_bf16 v[24:27], v[68:71], v[248:251], v[24:27]
    ds_read_b64_tr_b16 v[62:63], v123 offset:59392
    s_xor_b32 s52, s51, 61440
    buffer_load_dwordx4 v[216:219], v3, s[40:43], s52 offen offset:0 sc1
    s_waitcnt lgkmcnt(8)
    v_mfma_f32_16x16x32_bf16 v[80:83], v[72:75], v[248:251], v[80:83]
    v_add_u32 v120, 0xffff0000, v120
    v_add_u32 v121, 0xffff0000, v121
    ds_read_b64_tr_b16 v[64:65], v120 offset:32768
    v_mfma_f32_16x16x32_bf16 v[84:87], v[72:75], v[252:255], v[84:87]
    ds_read_b64_tr_b16 v[66:67], v120 offset:34816
    v_mfma_f32_16x16x32_bf16 v[92:95], v[76:79], v[252:255], v[92:95]
    ds_read_b64_tr_b16 v[68:69], v121 offset:32768
    v_mfma_f32_16x16x32_bf16 v[88:91], v[76:79], v[248:251], v[88:91]
    ds_read_b64_tr_b16 v[70:71], v121 offset:34816
    buffer_load_dwordx4 v[220:223], v3, s[40:43], s52 offen offset:1024 sc1
    s_waitcnt vmcnt(10) lgkmcnt(8)
    v_mfma_f32_16x16x32_bf16 v[16:19], v[48:51], v[32:35], v[16:19]
    v_add_u32 v122, 0xffff0000, v122
    v_add_u32 v123, 0xffff0000, v123
    ds_read_b64_tr_b16 v[72:73], v122 offset:32768
    v_mfma_f32_16x16x32_bf16 v[20:23], v[48:51], v[36:39], v[20:23]
    ds_read_b64_tr_b16 v[74:75], v122 offset:34816
    v_mfma_f32_16x16x32_bf16 v[28:31], v[52:55], v[36:39], v[28:31]
    ds_read_b64_tr_b16 v[76:77], v123 offset:32768
    v_mfma_f32_16x16x32_bf16 v[24:27], v[52:55], v[32:35], v[24:27]
    ds_read_b64_tr_b16 v[78:79], v123 offset:34816
    buffer_load_dwordx4 v[224:227], v3, s[40:43], s60 offen offset:0 sc1
    s_waitcnt lgkmcnt(8)
    v_mfma_f32_16x16x32_bf16 v[80:83], v[56:59], v[32:35], v[80:83]
    ds_read_b64_tr_b16 v[48:49], v120 offset:40960
    v_mfma_f32_16x16x32_bf16 v[84:87], v[56:59], v[36:39], v[84:87]
    ds_read_b64_tr_b16 v[50:51], v120 offset:43008
    v_mfma_f32_16x16x32_bf16 v[92:95], v[60:63], v[36:39], v[92:95]
    ds_read_b64_tr_b16 v[52:53], v121 offset:40960
    v_mfma_f32_16x16x32_bf16 v[88:91], v[60:63], v[32:35], v[88:91]
    ds_read_b64_tr_b16 v[54:55], v121 offset:43008
    buffer_load_dwordx4 v[228:231], v3, s[40:43], s60 offen offset:1024 sc1
    s_waitcnt vmcnt(10) lgkmcnt(8)
    v_mfma_f32_16x16x32_bf16 v[16:19], v[64:67], v[40:43], v[16:19]
    ds_read_b64_tr_b16 v[56:57], v122 offset:40960
    v_mfma_f32_16x16x32_bf16 v[20:23], v[64:67], v[44:47], v[20:23]
    ds_read_b64_tr_b16 v[58:59], v122 offset:43008
    v_mfma_f32_16x16x32_bf16 v[28:31], v[68:71], v[44:47], v[28:31]
    ds_read_b64_tr_b16 v[60:61], v123 offset:40960
    v_mfma_f32_16x16x32_bf16 v[24:27], v[68:71], v[40:43], v[24:27]
    ds_read_b64_tr_b16 v[62:63], v123 offset:43008
    buffer_load_dwordx4 v[232:235], v3, s[40:43], s61 offen offset:0 sc1
    s_waitcnt lgkmcnt(8)
    v_mfma_f32_16x16x32_bf16 v[80:83], v[72:75], v[40:43], v[80:83]
    ds_read_b64_tr_b16 v[64:65], v120 offset:49152
    v_mfma_f32_16x16x32_bf16 v[84:87], v[72:75], v[44:47], v[84:87]
    ds_read_b64_tr_b16 v[66:67], v120 offset:51200
    v_mfma_f32_16x16x32_bf16 v[92:95], v[76:79], v[44:47], v[92:95]
    ds_read_b64_tr_b16 v[68:69], v121 offset:49152
    v_mfma_f32_16x16x32_bf16 v[88:91], v[76:79], v[40:43], v[88:91]
    ds_read_b64_tr_b16 v[70:71], v121 offset:51200
    buffer_load_dwordx4 v[236:239], v3, s[40:43], s61 offen offset:1024 sc1
    s_waitcnt vmcnt(10) lgkmcnt(8)
    v_mfma_f32_16x16x32_bf16 v[16:19], v[48:51], v[192:195], v[16:19]
    ds_read_b64_tr_b16 v[72:73], v122 offset:49152
    v_mfma_f32_16x16x32_bf16 v[20:23], v[48:51], v[196:199], v[20:23]
    ds_read_b64_tr_b16 v[74:75], v122 offset:51200
    v_mfma_f32_16x16x32_bf16 v[28:31], v[52:55], v[196:199], v[28:31]
    ds_read_b64_tr_b16 v[76:77], v123 offset:49152
    v_mfma_f32_16x16x32_bf16 v[24:27], v[52:55], v[192:195], v[24:27]
    ds_read_b64_tr_b16 v[78:79], v123 offset:51200
    buffer_load_dwordx4 v[240:243], v3, s[40:43], s62 offen offset:0 sc1
    s_waitcnt lgkmcnt(8)
    v_mfma_f32_16x16x32_bf16 v[80:83], v[56:59], v[192:195], v[80:83]
    ds_read_b64_tr_b16 v[48:49], v120 offset:57344
    v_mfma_f32_16x16x32_bf16 v[84:87], v[56:59], v[196:199], v[84:87]
    ds_read_b64_tr_b16 v[50:51], v120 offset:59392
    v_mfma_f32_16x16x32_bf16 v[92:95], v[60:63], v[196:199], v[92:95]
    ds_read_b64_tr_b16 v[52:53], v121 offset:57344
    v_mfma_f32_16x16x32_bf16 v[88:91], v[60:63], v[192:195], v[88:91]
    ds_read_b64_tr_b16 v[54:55], v121 offset:59392
    buffer_load_dwordx4 v[244:247], v3, s[40:43], s62 offen offset:1024 sc1
    s_waitcnt vmcnt(10) lgkmcnt(8)
    v_mfma_f32_16x16x32_bf16 v[16:19], v[64:67], v[200:203], v[16:19]
    ds_read_b64_tr_b16 v[56:57], v122 offset:57344
    v_mfma_f32_16x16x32_bf16 v[20:23], v[64:67], v[204:207], v[20:23]
    ds_read_b64_tr_b16 v[58:59], v122 offset:59392
    v_mfma_f32_16x16x32_bf16 v[28:31], v[68:71], v[204:207], v[28:31]
    ds_read_b64_tr_b16 v[60:61], v123 offset:57344
    v_mfma_f32_16x16x32_bf16 v[24:27], v[68:71], v[200:203], v[24:27]
    ds_read_b64_tr_b16 v[62:63], v123 offset:59392
    s_mov_b64 exec, 1
    ds_add_u32 v127, v1 offset:12
    s_mov_b64 exec, -1
    buffer_load_dwordx4 v[248:251], v3, s[40:43], s63 offen offset:0 sc1
    s_waitcnt lgkmcnt(9)
    v_mfma_f32_16x16x32_bf16 v[80:83], v[72:75], v[200:203], v[80:83]
    ds_read_b64_tr_b16 v[64:65], v120 offset:0
    v_mfma_f32_16x16x32_bf16 v[84:87], v[72:75], v[204:207], v[84:87]
    ds_read_b64_tr_b16 v[66:67], v120 offset:2048
    v_mfma_f32_16x16x32_bf16 v[92:95], v[76:79], v[204:207], v[92:95]
    ds_read_b64_tr_b16 v[68:69], v121 offset:0
    v_mfma_f32_16x16x32_bf16 v[88:91], v[76:79], v[200:203], v[88:91]
    ds_read_b64_tr_b16 v[70:71], v121 offset:2048
    buffer_load_dwordx4 v[252:255], v3, s[40:43], s63 offen offset:1024 sc1
    s_waitcnt vmcnt(10) lgkmcnt(9)
    v_mfma_f32_16x16x32_bf16 v[16:19], v[48:51], v[208:211], v[16:19]
    ds_read_b64_tr_b16 v[72:73], v122 offset:0
    v_mfma_f32_16x16x32_bf16 v[20:23], v[48:51], v[212:215], v[20:23]
    ds_read_b64_tr_b16 v[74:75], v122 offset:2048
    v_mfma_f32_16x16x32_bf16 v[28:31], v[52:55], v[212:215], v[28:31]
    ds_read_b64_tr_b16 v[76:77], v123 offset:0
    v_mfma_f32_16x16x32_bf16 v[24:27], v[52:55], v[208:211], v[24:27]
    ds_read_b64_tr_b16 v[78:79], v123 offset:2048
    buffer_load_dwordx4 v[32:35], v3, s[40:43], s64 offen offset:0 sc1
    s_waitcnt lgkmcnt(9)
    v_mfma_f32_16x16x32_bf16 v[80:83], v[56:59], v[208:211], v[80:83]
    ds_read_b64_tr_b16 v[48:49], v120 offset:8192
    v_mfma_f32_16x16x32_bf16 v[84:87], v[56:59], v[212:215], v[84:87]
    ds_read_b64_tr_b16 v[50:51], v120 offset:10240
    v_mfma_f32_16x16x32_bf16 v[92:95], v[60:63], v[212:215], v[92:95]
    ds_read_b64_tr_b16 v[52:53], v121 offset:8192
    v_mfma_f32_16x16x32_bf16 v[88:91], v[60:63], v[208:211], v[88:91]
    ds_read_b64_tr_b16 v[54:55], v121 offset:10240
    buffer_load_dwordx4 v[36:39], v3, s[40:43], s64 offen offset:1024 sc1
    s_waitcnt vmcnt(10) lgkmcnt(8)
    v_mfma_f32_16x16x32_bf16 v[16:19], v[64:67], v[216:219], v[16:19]
    ds_read_b64_tr_b16 v[56:57], v122 offset:8192
    v_mfma_f32_16x16x32_bf16 v[20:23], v[64:67], v[220:223], v[20:23]
    ds_read_b64_tr_b16 v[58:59], v122 offset:10240
    v_mfma_f32_16x16x32_bf16 v[28:31], v[68:71], v[220:223], v[28:31]
    ds_read_b64_tr_b16 v[60:61], v123 offset:8192
    v_mfma_f32_16x16x32_bf16 v[24:27], v[68:71], v[216:219], v[24:27]
    ds_read_b64_tr_b16 v[62:63], v123 offset:10240
    s_waitcnt lgkmcnt(8)
    v_mfma_f32_16x16x32_bf16 v[80:83], v[72:75], v[216:219], v[80:83]
    ds_read_b64_tr_b16 v[64:65], v120 offset:16384
    v_mfma_f32_16x16x32_bf16 v[84:87], v[72:75], v[220:223], v[84:87]
    ds_read_b64_tr_b16 v[66:67], v120 offset:18432
    v_mfma_f32_16x16x32_bf16 v[92:95], v[76:79], v[220:223], v[92:95]
    ds_read_b64_tr_b16 v[68:69], v121 offset:16384
    v_mfma_f32_16x16x32_bf16 v[88:91], v[76:79], v[216:219], v[88:91]
    ds_read_b64_tr_b16 v[70:71], v121 offset:18432
    s_waitcnt vmcnt(8) lgkmcnt(8)
    v_mfma_f32_16x16x32_bf16 v[16:19], v[48:51], v[224:227], v[16:19]
    ds_read_b64_tr_b16 v[72:73], v122 offset:16384
    v_mfma_f32_16x16x32_bf16 v[20:23], v[48:51], v[228:231], v[20:23]
    ds_read_b64_tr_b16 v[74:75], v122 offset:18432
    v_mfma_f32_16x16x32_bf16 v[28:31], v[52:55], v[228:231], v[28:31]
    ds_read_b64_tr_b16 v[76:77], v123 offset:16384
    v_mfma_f32_16x16x32_bf16 v[24:27], v[52:55], v[224:227], v[24:27]
    ds_read_b64_tr_b16 v[78:79], v123 offset:18432
    s_waitcnt lgkmcnt(8)
    v_mfma_f32_16x16x32_bf16 v[80:83], v[56:59], v[224:227], v[80:83]
    ds_read_b64_tr_b16 v[48:49], v120 offset:24576
    v_mfma_f32_16x16x32_bf16 v[84:87], v[56:59], v[228:231], v[84:87]
    ds_read_b64_tr_b16 v[50:51], v120 offset:26624
    v_mfma_f32_16x16x32_bf16 v[92:95], v[60:63], v[228:231], v[92:95]
    ds_read_b64_tr_b16 v[52:53], v121 offset:24576
    v_mfma_f32_16x16x32_bf16 v[88:91], v[60:63], v[224:227], v[88:91]
    ds_read_b64_tr_b16 v[54:55], v121 offset:26624
    s_waitcnt vmcnt(6) lgkmcnt(8)
    v_mfma_f32_16x16x32_bf16 v[16:19], v[64:67], v[232:235], v[16:19]
    ds_read_b64_tr_b16 v[56:57], v122 offset:24576
    v_mfma_f32_16x16x32_bf16 v[20:23], v[64:67], v[236:239], v[20:23]
    ds_read_b64_tr_b16 v[58:59], v122 offset:26624
    v_mfma_f32_16x16x32_bf16 v[28:31], v[68:71], v[236:239], v[28:31]
    ds_read_b64_tr_b16 v[60:61], v123 offset:24576
    v_mfma_f32_16x16x32_bf16 v[24:27], v[68:71], v[232:235], v[24:27]
    ds_read_b64_tr_b16 v[62:63], v123 offset:26624
    ds_read_b32 v8, v127 offset:12
    s_waitcnt lgkmcnt(9)
    v_mfma_f32_16x16x32_bf16 v[80:83], v[72:75], v[232:235], v[80:83]
    v_add_u32 v120, 0x20000, v120
    v_add_u32 v121, 0x20000, v121
    ds_read_b64_tr_b16 v[64:65], v120 offset:8192
    v_mfma_f32_16x16x32_bf16 v[84:87], v[72:75], v[236:239], v[84:87]
    ds_read_b64_tr_b16 v[66:67], v120 offset:10240
    v_mfma_f32_16x16x32_bf16 v[92:95], v[76:79], v[236:239], v[92:95]
    ds_read_b64_tr_b16 v[68:69], v121 offset:8192
    v_mfma_f32_16x16x32_bf16 v[88:91], v[76:79], v[232:235], v[88:91]
    ds_read_b64_tr_b16 v[70:71], v121 offset:10240
    s_waitcnt lgkmcnt(4)
    v_cmp_gt_u32 vcc, 4, v8
    s_nop 1
    s_cbranch_vccnz L_spW3
L_spdW3:
    s_waitcnt vmcnt(4)
    v_mfma_f32_16x16x32_bf16 v[16:19], v[48:51], v[240:243], v[16:19]
    v_add_u32 v122, 0x20000, v122
    v_add_u32 v123, 0x20000, v123
    ds_read_b64_tr_b16 v[72:73], v122 offset:8192
    v_mfma_f32_16x16x32_bf16 v[20:23], v[48:51], v[244:247], v[20:23]
    ds_read_b64_tr_b16 v[74:75], v122 offset:10240
    v_mfma_f32_16x16x32_bf16 v[28:31], v[52:55], v[244:247], v[28:31]
    ds_read_b64_tr_b16 v[76:77], v123 offset:8192
    v_mfma_f32_16x16x32_bf16 v[24:27], v[52:55], v[240:243], v[24:27]
    ds_read_b64_tr_b16 v[78:79], v123 offset:10240
    v_mfma_f32_16x16x32_bf16 v[80:83], v[56:59], v[240:243], v[80:83]
    ds_read_b64_tr_b16 v[48:49], v120 offset:16384
    v_mfma_f32_16x16x32_bf16 v[84:87], v[56:59], v[244:247], v[84:87]
    ds_read_b64_tr_b16 v[50:51], v120 offset:18432
    v_mfma_f32_16x16x32_bf16 v[92:95], v[60:63], v[244:247], v[92:95]
    ds_read_b64_tr_b16 v[52:53], v121 offset:16384
    v_mfma_f32_16x16x32_bf16 v[88:91], v[60:63], v[240:243], v[88:91]
    ds_read_b64_tr_b16 v[54:55], v121 offset:18432
    s_waitcnt vmcnt(2) lgkmcnt(8)
    v_mfma_f32_16x16x32_bf16 v[16:19], v[64:67], v[248:251], v[16:19]
    ds_read_b64_tr_b16 v[56:57], v122 offset:16384
    v_mfma_f32_16x16x32_bf16 v[20:23], v[64:67], v[252:255], v[20:23]
    ds_read_b64_tr_b16 v[58:59], v122 offset:18432
    v_mfma_f32_16x16x32_bf16 v[28:31], v[68:71], v[252:255], v[28:31]
    ds_read_b64_tr_b16 v[60:61], v123 offset:16384
    v_mfma_f32_16x16x32_bf16 v[24:27], v[68:71], v[248:251], v[24:27]
    ds_read_b64_tr_b16 v[62:63], v123 offset:18432
    s_waitcnt lgkmcnt(8)
    v_mfma_f32_16x16x32_bf16 v[80:83], v[72:75], v[248:251], v[80:83]
    v_mfma_f32_16x16x32_bf16 v[84:87], v[72:75], v[252:255], v[84:87]
    v_mfma_f32_16x16x32_bf16 v[92:95], v[76:79], v[252:255], v[92:95]
    v_mfma_f32_16x16x32_bf16 v[88:91], v[76:79], v[248:251], v[88:91]
    s_waitcnt vmcnt(0) lgkmcnt(4)
    v_mfma_f32_16x16x32_bf16 v[16:19], v[48:51], v[32:35], v[16:19]
    v_mfma_f32_16x16x32_bf16 v[20:23], v[48:51], v[36:39], v[20:23]
    v_mfma_f32_16x16x32_bf16 v[28:31], v[52:55], v[36:39], v[28:31]
    v_mfma_f32_16x16x32_bf16 v[24:27], v[52:55], v[32:35], v[24:27]
    s_waitcnt lgkmcnt(0)
    v_mfma_f32_16x16x32_bf16 v[80:83], v[56:59], v[32:35], v[80:83]
    v_mfma_f32_16x16x32_bf16 v[84:87], v[56:59], v[36:39], v[84:87]
    s_nop 1
    ds_write_b128 v107, v[16:19] offset:0
    v_mfma_f32_16x16x32_bf16 v[92:95], v[60:63], v[36:39], v[92:95]
    ds_write_b128 v107, v[20:23] offset:4352
    v_mfma_f32_16x16x32_bf16 v[88:91], v[60:63], v[32:35], v[88:91]
L_g2done:
    ds_write_b128 v107, v[28:31] offset:4416
    ds_write_b128 v107, v[24:27] offset:64
    ds_write_b128 v107, v[80:83] offset:128
    ds_write_b128 v107, v[84:87] offset:4480
    s_nop 1
    ds_write_b128 v107, v[92:95] offset:4544
    s_nop 0
    ds_write_b128 v107, v[88:91] offset:192
    s_cmp_lg_u32 s27, 0x7f000000
    s_cbranch_scc1 L_bumpR
L_bumpRd:
    s_waitcnt lgkmcnt(0)
    s_barrier
    s_endpgm
L_helper:
    s_setprio 2
    s_lshl_b32 s39, s33, 7
    s_add_u32 s64, s39, 10616832
    s_lshl_b32 s65, s34, 2
    s_add_u32 s65, s65, s39
    s_add_u32 s66, s65, s36
    s_lshl_b32 s66, s66, 11
    s_or_b32 s67, s66, 2048
    s_sub_u32 s67, s67, 4
    s_load_dword s28, s[30:31], s64
    s_load_dword s16, s[14:15], s65
    s_load_dword s17, s[12:13], s67
    v_lshl_add_u32 v2, v3, 4, v2
    s_lshl_b32 s68, s34, 16
    s_lshl_b32 s69, s36, 5
    s_add_u32 s69, s69, s39
    s_add_u32 s68, s68, s69
    v_add_u32 v3, s68, v2
    v_subrev_u32 v2, 4096, v3
    v_and_b32 v9, 15, v0
    s_lshl_b32 s69, s69, 2
    v_lshl_add_u32 v17, v9, 3, s69
    v_lshl_add_u32 v94, v5, 4, s39
    v_lshrrev_b32 v136, 4, v0
    v_lshrrev_b32 v137, 2, v4
    s_mul_i32 s35, s33, 43
    s_add_u32 s35, s35, 3
    s_lshr_b32 s35, s35, 3
    s_and_b32 s37, s35, 1
    s_lshl_b32 s68, s36, 6
    v_add_u32 v6, s68, v4
    v_mul_u32_u24 v6, 5504, v6
    v_lshlrev_b32 v7, 1, v137
    v_xor_b32 v7, v7, v5
    v_lshl_add_u32 v6, v7, 4, v6
    s_lshl_b32 s68, s35, 6
    s_mul_i32 s69, s37, 2752
    s_add_u32 s1, s68, s69
    v_add_u32 v124, s1, v6
    s_sub_u32 s68, s68, s69
    s_add_u32 s68, s68, 2688
    v_add_u32 v125, s68, v6
    s_lshl_b32 s71, s36, 13
    s_mov_b32 s48, s6
    s_mov_b32 s49, s7
    s_mov_b32 s50, 0x200000
    s_mov_b32 s51, 0x20000
    s_mov_b32 s52, s8
    s_mov_b32 s53, s9
    s_mov_b32 s54, 0x200000
    s_mov_b32 s55, 0x20000
    v_and_b32 v6, 6, v4
    v_xor_b32 v6, v5, v6
    v_lshlrev_b32 v6, 4, v6
    v_lshl_add_u32 v6, v4, 10, v6
    s_lshl_b32 s68, s36, 13
    s_lshl_b32 s69, s33, 7
    s_add_u32 s68, s68, s69
    v_add_u32 v126, s68, v6
    v_mov_b32 v127, 159744
    v_mov_b32 v1, 1
    s_mov_b32 s40, s30
    s_mov_b32 s41, s31
    s_mov_b32 s42, 0xa22000
    s_mov_b32 s43, 0x20000
    s_mov_b32 s44, s22
    s_mov_b32 s45, s23
    s_mov_b32 s46, 0x158000
    s_mov_b32 s47, 0x20000
    s_lshr_b32 s21, s65, 2
    v_lshlrev_b32 v250, 4, v0
    v_add_u32 v92, s66, v250
    v_and_b32 v137, 1, v4
    v_lshrrev_b32 v138, 1, v4
    v_lshl_add_u32 v139, v137, 4, v138
    v_and_b32 v140, 3, v0
    v_lshlrev_b32 v141, 10, v139
    v_lshl_add_u32 v141, v5, 4, v141
    s_lshl_b32 s68, s34, 16
    s_add_u32 s68, s68, s39
    s_lshl_b32 s69, s36, 12
    s_add_u32 s68, s68, s69
    v_add_u32 v123, s68, v141
    s_add_u32 s69, s71, 131072
    v_lshlrev_b32 v6, 9, v136
    v_lshl_add_u32 v6, v9, 3, v6
    v_add_u32 v6, s69, v6
    s_lshl_b32 s1, s33, 3
    s_mov_b32 s18, 0x160b0b00
    s_mov_b32 s19, 0x16160000
    s_lshr_b64 s[18:19], s[18:19], s1
    s_and_b32 s18, s18, 0xff
    s_lshl_b32 s68, s34, 2
    s_add_u32 s68, s68, s36
    s_cmp_lt_u32 s33, 4
    s_cselect_b32 s69, 33, 43
    s_cselect_b32 s19, 3, 4
    s_mul_i32 s69, s68, s69
    s_mov_b32 s0, 16384
    s_cselect_b32 s0, 21846, s0
    s_add_u32 s69, s69, s18
    v_add_u32 v88, s69, v0
    v_mul_u32_u24 v89, s0, v88
    v_lshrrev_b32 v89, 16, v89
    s_sub_u32 s19, 8, s19
    v_mad_u32_u24 v88, v89, s19, v88
    s_and_b32 s69, s33, 4
    v_add_lshl_u32 v88, s69, v88, 7
    s_mov_b32 s18, 0x3a1e1e00
    s_mov_b32 s19, 0x56565656
    s_lshr_b64 s[18:19], s[18:19], s1
    s_and_b32 s18, s18, 0xff
    s_and_b32 s68, s68, 31
    s_mul_i32 s68, s68, 86
    s_add_u32 s68, s68, s18
    s_mov_b32 s18, 0xb0b000b
    s_mov_b32 s19, 0x15001600
    s_lshr_b64 s[18:19], s[18:19], s1
    s_and_b32 s18, s18, 0xff
    s_sub_u32 s68, s68, s18
    v_add_u32 v89, s68, v0
    v_and_b32 v141, 1, v89
    v_lshrrev_b32 v89, 1, v89
    v_lshlrev_b32 v89, 10, v89
    v_lshl_add_u32 v89, v141, 6, v89
    v_cmp_gt_u32 vcc, s18, v0
    v_add_u32 v89, 384, v89
    v_lshrrev_b32 v18, 2, v9
    v_cndmask_b32 v88, v89, v88, vcc
    s_mov_b32 s18, 0x27270029
    s_mov_b32 s19, 0x15001600
    s_lshr_b64 s[18:19], s[18:19], s1
    s_and_b32 s18, s18, 0xff
    s_bfm_b64 s[18:19], s18, 0
    v_mul_u32_u24 v18, 16896, v18
    v_lshl_add_u32 v18, v136, 6, v18
    v_lshl_add_u32 v18, v140, 4, v18
    s_lshl_b32 s68, s33, 2
    s_add_u32 s68, s68, s36
    s_mul_i32 s68, s68, 67584
    s_lshl_b32 s69, s34, 8
    s_add_u32 s22, s68, s69
    v_add_u32 v18, s22, v18
    s_mul_i32 s68, s33, 43
    s_add_u32 s68, s68, 46
    s_lshr_b32 s68, s68, 3
    s_sub_u32 s68, s68, s35
    s_cmp_eq_u32 s68, 6
    s_mov_b32 s23, 0x7f000000
    s_cselect_b32 s23, 384, s23
    s_and_b32 s37, s36, 1
    s_lshr_b32 s20, s36, 1
    v_lshlrev_b32 v141, 8, v137
    v_lshl_add_u32 v141, v138, 3, v141
    s_lshl_b32 s68, s20, 7
    s_lshl_b32 s69, s37, 5
    s_add_u32 s68, s68, s69
    s_add_u32 s68, s68, 66560
    v_add_u32 v248, s68, v141
    v_lshl_add_u32 v251, v136, 3, v9
    v_sub_u32 v251, 15, v251
    s_mov_b32 s64, s26
    s_mov_b32 s65, s27
    s_mov_b32 s66, 0x200000
    s_mov_b32 s67, 0x20000
    s_lshl_b32 s68, s33, 12
    s_add_u32 s68, s68, 10125312
    s_lshr_b32 s1, s34, 3
    s_lshl_b32 s26, s1, 2
    s_add_u32 s26, s26, s36
    s_lshl_b32 s26, s26, 8
    s_add_u32 s26, s26, s68
    s_add_u32 s70, s26, 128
    s_lshl_b32 s35, s36, 2
    s_add_u32 s35, s35, s1
    s_lshl_b32 s35, s35, 8
    s_add_u32 s35, s35, s68
    s_and_b32 s1, s34, 7
    s_lshl_b32 s1, s1, 2
    s_add_u32 s35, s35, s1
    s_add_u32 s27, s39, 10616832
    s_or_b32 s68, s34, s36
    s_cselect_b32 s27, 0x7f000000, s27
    s_setprio 0
    s_add_u32 m0, s71, 131072
    s_movk_i32 s68, 28672
    buffer_load_dwordx4 v2, s[48:51], 0 offen lds
    s_add_u32 m0, s71, 132096
    s_mov_b32 s69, 61440
    buffer_load_dwordx4 v3, s[48:51], s68 offen lds
    s_add_u32 m0, s71, 133120
    s_mov_b64 exec, 0xff
    buffer_load_dwordx4 v3, s[48:51], s69 offen lds
    s_mov_b64 exec, -1
    s_add_u32 m0, s71, 133632
    s_mov_b32 s68, 32768
    buffer_load_dwordx4 v3, s[52:55], 0 offen lds
    s_add_u32 m0, s71, 134656
    s_nop 0
    buffer_load_dwordx4 v3, s[52:55], s68 offen lds
    global_load_dwordx2 v[10:11], v17, s[10:11]
    global_load_dwordx4 v[108:111], v94, s[24:25]
    s_mov_b32 s48, s12
    s_mov_b32 s49, s13
    s_mov_b32 s50, 0x200000
    s_mov_b32 s51, 0x20000
    s_mov_b64 exec, 0xffffff
    buffer_load_dword v90, v87, s[56:59], 0 offen
    s_mov_b64 exec, -1
    s_movk_i32 s68, 0
    s_add_u32 m0, s71, 98304
    s_nop 0
    buffer_load_dwordx4 v124, s[56:59], s68 offen lds
    s_add_u32 m0, s71, 99328
    s_add_u32 s68, s68, 44032
    buffer_load_dwordx4 v124, s[56:59], s68 offen lds
    s_add_u32 m0, s71, 100352
    s_add_u32 s68, s68, 44032
    buffer_load_dwordx4 v124, s[56:59], s68 offen lds
    s_add_u32 m0, s71, 101376
    s_add_u32 s68, s68, 44032
    buffer_load_dwordx4 v124, s[56:59], s68 offen lds
    s_movk_i32 s68, 0
    s_add_u32 m0, s71, 65536
    s_nop 0
    s_mov_b32 exec_lo, 0xf0f0f0f0
    s_mov_b32 exec_hi, 0xf0f0f0f0
    buffer_load_dwordx4 v125, s[56:59], s68 offen lds
    s_mov_b64 exec, -1
    s_add_u32 m0, s71, 66560
    s_add_u32 s68, s68, 44032
    s_mov_b32 exec_lo, 0xf0f0f0f0
    s_mov_b32 exec_hi, 0xf0f0f0f0
    buffer_load_dwordx4 v125, s[56:59], s68 offen lds
    s_mov_b64 exec, -1
    s_add_u32 m0, s71, 67584
    s_add_u32 s68, s68, 44032
    s_mov_b32 exec_lo, 0xf0f0f0f0
    s_mov_b32 exec_hi, 0xf0f0f0f0
    buffer_load_dwordx4 v125, s[56:59], s68 offen lds
    s_mov_b64 exec, -1
    s_add_u32 m0, s71, 68608
    s_add_u32 s68, s68, 44032
    s_mov_b32 exec_lo, 0xf0f0f0f0
    s_mov_b32 exec_hi, 0xf0f0f0f0
    buffer_load_dwordx4 v125, s[56:59], s68 offen lds
    s_mov_b64 exec, -1
    s_lshl_b32 s69, s36, 10
    s_setprio 1
    s_waitcnt vmcnt(9)
    ds_read_b64_tr_b16 v[20:21], v6 offset:0
    ds_read_b64_tr_b16 v[22:23], v6 offset:128
    ds_read_b64_tr_b16 v[24:25], v6 offset:256
    ds_read_b64_tr_b16 v[26:27], v6 offset:384
    ds_read_b64_tr_b16 v[28:29], v6 offset:512
    ds_read_b64_tr_b16 v[30:31], v6 offset:2560
    ds_read_b64_tr_b16 v[32:33], v6 offset:2688
    ds_read_b64_tr_b16 v[34:35], v6 offset:2816
    ds_read_b64_tr_b16 v[36:37], v6 offset:2944
    v_alignbit_b32 v12, v10, v10, 16
    v_alignbit_b32 v13, v11, v11, 16
    v_and_b32 v14, 0xffff, v10
    v_alignbit_b32 v15, v12, v13, 16
    v_and_b32 v16, 0xffff0000, v11
    s_waitcnt lgkmcnt(0)
    s_movk_i32 s68, 128
    s_waitcnt lgkmcnt(0)
    s_add_u32 s28, s28, 0x9e3779b9
    s_mov_b32 s29, s28
    v_mov_b32 v249, s28
    s_add_u32 m0, s71, 131072
    s_nop 0
    buffer_load_dwordx4 v125, s[56:59], s68 offen lds
    v_dot2_f32_bf16 v40, v20, v16, 0
    v_dot2_f32_bf16 v41, v21, v13, 0
    v_dot2_f32_bf16 v42, v21, v16, 0
    v_dot2_f32_bf16 v43, v22, v13, 0
    v_dot2_f32_bf16 v44, v22, v16, 0
    v_dot2_f32_bf16 v45, v23, v13, 0
    v_dot2_f32_bf16 v46, v23, v16, 0
    v_dot2_f32_bf16 v47, v24, v13, 0
    v_dot2_f32_bf16 v48, v24, v16, 0
    s_add_u32 m0, s71, 132096
    s_add_u32 s68, s68, 44032
    buffer_load_dwordx4 v125, s[56:59], s68 offen lds
    v_dot2_f32_bf16 v49, v25, v13, 0
    v_dot2_f32_bf16 v50, v25, v16, 0
    v_dot2_f32_bf16 v51, v26, v13, 0
    v_dot2_f32_bf16 v52, v26, v16, 0
    v_dot2_f32_bf16 v53, v27, v13, 0
    v_dot2_f32_bf16 v54, v27, v16, 0
    v_dot2_f32_bf16 v55, v28, v13, 0
    v_dot2_f32_bf16 v40, v21, v15, v40
    v_dot2_f32_bf16 v41, v22, v12, v41
    s_waitcnt vmcnt(10)
    s_add_u32 m0, s71, 133120
    s_add_u32 s68, s68, 44032
    buffer_load_dwordx4 v125, s[56:59], s68 offen lds
    v_dot2_f32_bf16 v42, v22, v15, v42
    v_dot2_f32_bf16 v43, v23, v12, v43
    v_dot2_f32_bf16 v44, v23, v15, v44
    v_dot2_f32_bf16 v45, v24, v12, v45
    v_dot2_f32_bf16 v46, v24, v15, v46
    v_dot2_f32_bf16 v47, v25, v12, v47
    v_dot2_f32_bf16 v48, v25, v15, v48
    v_dot2_f32_bf16 v49, v26, v12, v49
    v_dot2_f32_bf16 v50, v26, v15, v50
    s_waitcnt vmcnt(10)
    s_add_u32 m0, s71, 134144
    s_add_u32 s68, s68, 44032
    buffer_load_dwordx4 v125, s[56:59], s68 offen lds
    v_dot2_f32_bf16 v51, v27, v12, v51
    v_dot2_f32_bf16 v52, v27, v15, v52
    v_dot2_f32_bf16 v53, v28, v12, v53
    v_dot2_f32_bf16 v54, v28, v15, v54
    v_dot2_f32_bf16 v55, v29, v12, v55
    v_dot2_f32_bf16 v40, v22, v14, v40
    v_dot2_f32_bf16 v42, v23, v14, v42
    v_dot2_f32_bf16 v44, v24, v14, v44
    s_mov_b32 s68, 132096
    s_barrier
    s_waitcnt vmcnt(10)
    s_add_u32 m0, s71, 102400
    s_add_u32 s68, s68, 44032
    buffer_load_dwordx4 v124, s[56:59], s68 offen lds
    v_dot2_f32_bf16 v46, v25, v14, v46
    v_dot2_f32_bf16 v48, v26, v14, v48
    v_dot2_f32_bf16 v50, v27, v14, v50
    v_dot2_f32_bf16 v52, v28, v14, v52
    v_dot2_f32_bf16 v54, v29, v14, v54
    v_lshlrev_b32 v56, 16, v30
    v_and_b32 v57, 0xffff0000, v30
    v_lshlrev_b32 v58, 16, v31
    v_and_b32 v59, 0xffff0000, v31
    s_waitcnt vmcnt(10)
    s_add_u32 m0, s71, 103424
    s_add_u32 s68, s68, 44032
    buffer_load_dwordx4 v124, s[56:59], s68 offen lds
    v_lshlrev_b32 v60, 16, v32
    v_and_b32 v61, 0xffff0000, v32
    v_lshlrev_b32 v62, 16, v33
    v_and_b32 v63, 0xffff0000, v33
    v_lshlrev_b32 v64, 16, v34
    v_and_b32 v65, 0xffff0000, v34
    v_lshlrev_b32 v66, 16, v35
    v_and_b32 v67, 0xffff0000, v35
    v_lshlrev_b32 v68, 16, v36
    s_waitcnt vmcnt(10)
    s_add_u32 m0, s71, 104448
    s_add_u32 s68, s68, 44032
    buffer_load_dwordx4 v124, s[56:59], s68 offen lds
    v_and_b32 v69, 0xffff0000, v36
    v_lshlrev_b32 v70, 16, v37
    v_and_b32 v71, 0xffff0000, v37
    v_pk_mul_f32 v[40:41], v[40:41], v[56:57]
    v_pk_mul_f32 v[42:43], v[42:43], v[58:59]
    v_pk_mul_f32 v[44:45], v[44:45], v[60:61]
    v_pk_mul_f32 v[46:47], v[46:47], v[62:63]
    v_pk_mul_f32 v[48:49], v[48:49], v[64:65]
    v_pk_mul_f32 v[50:51], v[50:51], v[66:67]
    s_waitcnt vmcnt(10)
    s_add_u32 m0, s71, 105472
    s_add_u32 s68, s68, 44032
    buffer_load_dwordx4 v124, s[56:59], s68 offen lds
    v_pk_mul_f32 v[52:53], v[52:53], v[68:69]
    v_pk_mul_f32 v[54:55], v[54:55], v[70:71]
    v_cvt_pk_bf16_f32 v72, v47, v46
    v_cvt_pk_bf16_f32 v73, v45, v44
    v_cvt_pk_bf16_f32 v74, v43, v42
    v_cvt_pk_bf16_f32 v75, v41, v40
    v_cvt_pk_bf16_f32 v76, v55, v54
    v_cvt_pk_bf16_f32 v77, v53, v52
    s_mov_b32 s68, 132096
    s_waitcnt vmcnt(10)
    s_add_u32 m0, s71, 69632
    s_add_u32 s68, s68, 44032
    s_mov_b32 exec_lo, 0xf0f0f0f0
    s_mov_b32 exec_hi, 0xf0f0f0f0
    buffer_load_dwordx4 v125, s[56:59], s68 offen lds
    s_mov_b64 exec, -1
    v_cvt_pk_bf16_f32 v78, v51, v50
    v_cvt_pk_bf16_f32 v79, v49, v48
    s_mov_b32 vcc_lo, 0x33333333
    s_mov_b32 vcc_hi, 0x33333333
    v_cndmask_b32_dpp v80, v76, v72, vcc quad_perm:[2,3,0,1] row_mask:0xf bank_mask:0xf
    v_cndmask_b32_dpp v81, v77, v73, vcc quad_perm:[2,3,0,1] row_mask:0xf bank_mask:0xf
    v_cndmask_b32_dpp v82, v78, v74, vcc quad_perm:[2,3,0,1] row_mask:0xf bank_mask:0xf
    v_cndmask_b32_dpp v83, v79, v75, vcc quad_perm:[2,3,0,1] row_mask:0xf bank_mask:0xf
    s_not_b64 vcc, vcc
    v_cndmask_b32_dpp v84, v72, v76, vcc quad_perm:[2,3,0,1] row_mask:0xf bank_mask:0xf
    s_waitcnt vmcnt(10)
    s_add_u32 m0, s71, 70656
    s_add_u32 s68, s68, 44032
    s_mov_b32 exec_lo, 0xf0f0f0f0
    s_mov_b32 exec_hi, 0xf0f0f0f0
    buffer_load_dwordx4 v125, s[56:59], s68 offen lds
    s_mov_b64 exec, -1
    v_cndmask_b32_dpp v85, v73, v77, vcc quad_perm:[2,3,0,1] row_mask:0xf bank_mask:0xf
    v_cndmask_b32_dpp v86, v74, v78, vcc quad_perm:[2,3,0,1] row_mask:0xf bank_mask:0xf
    v_cndmask_b32_dpp v87, v75, v79, vcc quad_perm:[2,3,0,1] row_mask:0xf bank_mask:0xf
    s_lshl_b32 s1, s36, 3
    s_and_b32 s1, s1, 16
    s_lshr_b32 s16, s16, s1
    s_and_b32 s16, s16, 0xffff
    v_mov_b32 v122, s16
    s_mul_i32 s17, s17, s37
    v_mov_b32 v120, s17
    s_waitcnt vmcnt(10)
    s_add_u32 m0, s71, 71680
    s_add_u32 s68, s68, 44032
    s_mov_b32 exec_lo, 0xf0f0f0f0
    s_mov_b32 exec_hi, 0xf0f0f0f0
    buffer_load_dwordx4 v125, s[56:59], s68 offen lds
    s_mov_b64 exec, -1
    v_and_b32 v91, 1, v251
    v_lshlrev_b32 v91, 4, v91
    v_lshlrev_b32 v91, v91, v122
    v_lshrrev_b32 v251, 1, v251
    v_lshl_add_u32 v251, s37, 4, v251
    v_cmp_eq_u32 vcc, 0, v251
    v_mov_b32 v12, 0
    s_nop 0
    v_cndmask_b32 v252, 0, v91, vcc
    v_cmp_eq_u32 vcc, 1, v251
    v_mov_b32 v13, 0
    s_waitcnt vmcnt(10)
    s_add_u32 m0, s71, 72704
    s_add_u32 s68, s68, 44032
    s_mov_b32 exec_lo, 0xf0f0f0f0
    s_mov_b32 exec_hi, 0xf0f0f0f0
    buffer_load_dwordx4 v125, s[56:59], s68 offen lds
    s_mov_b64 exec, -1
    v_cndmask_b32 v253, 0, v91, vcc
    v_cmp_eq_u32 vcc, 2, v251
    v_mov_b32 v14, 0
    s_nop 0
    v_cndmask_b32 v254, 0, v91, vcc
    v_cmp_eq_u32 vcc, 3, v251
    v_mov_b32 v15, 0
    s_nop 0
    v_cndmask_b32 v255, 0, v91, vcc
    s_mov_b32 s68, 132224
    s_waitcnt vmcnt(10)
    s_add_u32 m0, s71, 135168
    s_add_u32 s68, s68, 44032
    buffer_load_dwordx4 v125, s[56:59], s68 offen lds
    s_waitcnt vmcnt(9)
    s_setprio 0
    s_barrier
    s_mov_b32 s68, 176256
    s_add_u32 m0, s71, 136192
    s_add_u32 s68, s68, 44032
    buffer_load_dwordx4 v125, s[56:59], s68 offen lds
    s_add_u32 m0, s71, 137216
    s_add_u32 s68, s68, 44032
    buffer_load_dwordx4 v125, s[56:59], s68 offen lds
    s_waitcnt vmcnt(10)
    s_add_u32 m0, s71, 138240
    s_add_u32 s68, s68, 44032
    buffer_load_dwordx4 v125, s[56:59], s68 offen lds
    ds_read_b64 v[96:97], v248
    ds_read_b64 v[98:99], v248 offset:512
    s_movk_i32 s68, 128
    s_waitcnt vmcnt(10)
    s_add_u32 m0, s71, 0
    s_nop 0
    buffer_load_dwordx4 v124, s[56:59], s68 offen lds
    s_waitcnt vmcnt(10)
    s_add_u32 m0, s71, 1024
    s_add_u32 s68, s68, 44032
    buffer_load_dwordx4 v124, s[56:59], s68 offen lds
    s_waitcnt vmcnt(10)
    s_add_u32 m0, s71, 2048
    s_add_u32 s68, s68, 44032
    buffer_load_dwordx4 v124, s[56:59], s68 offen lds
    s_waitcnt vmcnt(10)
    s_add_u32 m0, s71, 3072
    s_add_u32 s68, s68, 44032
    buffer_load_dwordx4 v124, s[56:59], s68 offen lds
    s_waitcnt vmcnt(10)
    s_add_u32 m0, s71, 4096
    s_add_u32 s68, s68, 44032
    buffer_load_dwordx4 v124, s[56:59], s68 offen lds
    s_waitcnt vmcnt(10)
    s_add_u32 m0, s71, 5120
    s_add_u32 s68, s68, 44032
    buffer_load_dwordx4 v124, s[56:59], s68 offen lds
    s_waitcnt vmcnt(10)
    s_add_u32 m0, s71, 6144
    s_add_u32 s68, s68, 44032
    buffer_load_dwordx4 v124, s[56:59], s68 offen lds
    s_waitcnt vmcnt(10)
    s_add_u32 m0, s71, 7168
    s_add_u32 s68, s68, 44032
    buffer_load_dwordx4 v124, s[56:59], s68 offen lds
    s_waitcnt vmcnt(8) lgkmcnt(0)
    s_barrier
    s_movk_i32 s68, 256
    s_add_u32 m0, s71, 32768
    s_nop 0
    buffer_load_dwordx4 v125, s[56:59], s68 offen lds
    s_add_u32 m0, s71, 33792
    s_add_u32 s68, s68, 44032
    buffer_load_dwordx4 v125, s[56:59], s68 offen lds
    s_waitcnt vmcnt(9)
    s_add_u32 m0, s71, 34816
    s_add_u32 s68, s68, 44032
    buffer_load_dwordx4 v125, s[56:59], s68 offen lds
    s_waitcnt vmcnt(9)
    s_add_u32 m0, s71, 35840
    s_add_u32 s68, s68, 44032
    buffer_load_dwordx4 v125, s[56:59], s68 offen lds
    s_waitcnt vmcnt(9)
    s_add_u32 m0, s71, 36864
    s_add_u32 s68, s68, 44032
    buffer_load_dwordx4 v125, s[56:59], s68 offen lds
    s_waitcnt vmcnt(9)
    s_add_u32 m0, s71, 37888
    s_add_u32 s68, s68, 44032
    buffer_load_dwordx4 v125, s[56:59], s68 offen lds
    s_waitcnt vmcnt(9)
    s_add_u32 m0, s71, 38912
    s_add_u32 s68, s68, 44032
    buffer_load_dwordx4 v125, s[56:59], s68 offen lds
    s_waitcnt vmcnt(9)
    s_add_u32 m0, s71, 39936
    s_add_u32 s68, s68, 44032
    buffer_load_dwordx4 v125, s[56:59], s68 offen lds
    s_cmp_eq_u32 s23, 384
    s_cbranch_scc1 L_h_six
    s_mov_b32 s1, 8448
    buffer_store_dwordx4 v[80:83], v18, s[40:43], 0 offen sc1
    buffer_store_dwordx4 v[84:87], v18, s[40:43], s1 offen sc1
    s_mov_b64 exec, s[18:19]
    buffer_load_dword v90, v88, s[44:47], 0 offen
    s_mov_b64 exec, -1
    s_mul_i32 s68, s21, 8448
    s_lshl_b32 s1, s36, 11
    s_add_u32 s68, s68, s1
    v_add_u32 v128, s68, v250
    v_lshrrev_b32 v141, 2, v9
    v_lshlrev_b32 v141, 8, v141
    v_lshl_add_u32 v141, v136, 6, v141
    v_lshl_add_u32 v141, v140, 4, v141
    s_add_u32 s68, s68, 2162688
    v_add_u32 v242, s68, v141
    v_and_b32 v142, 1, v0
    v_mul_u32_u24 v129, 4608, v142
    v_lshrrev_b32 v141, 1, v0
    v_lshl_add_u32 v129, v141, 4, v129
    s_add_u32 s68, s69, 83712
    v_add_u32 v129, s68, v129
    s_mul_i32 s38, s20, 8320
    s_add_u32 s38, s38, 66560
    s_mul_i32 s39, s20, 4608
    s_add_u32 s39, s39, 83200
    s_lshl_b32 s68, s37, 11
    s_add_u32 s68, s68, s38
    v_add_u32 v237, s68, v250
    v_add_u32 v238, s38, v250
    v_add_u32 v239, s39, v250
    v_lshrrev_b32 v141, 1, v9
    v_lshl_add_u32 v141, v136, 2, v141
    v_lshlrev_b32 v141, 2, v141
    v_mul_u32_u24 v143, 4160, v142
    v_sub_u32 v141, v141, v143
    s_lshl_b32 s1, s37, 8
    s_add_u32 s68, s1, s38
    s_add_u32 s68, s68, 4164
    v_add_u32 v232, s68, v141
    v_add_u32 v233, 1024, v232
    v_add_u32 v234, 2048, v232
    v_add_u32 v235, 3072, v232
    v_lshlrev_b32 v141, 1, v9
    v_sub_u32 v141, v141, v136
    v_lshlrev_b32 v141, 4, v141
    s_sub_u32 s68, s39, s1
    s_add_u32 s68, s68, 336
    v_add_u32 v236, s68, v141
    s_add_u32 s68, s71, 65536
    v_add_u32 v240, s68, v250
    s_add_u32 s68, s69, 65536
    v_add_u32 v241, s68, v250
    v_mul_u32_u24 v141, 8448, v136
    s_lshl_b32 s1, s36, 1
    v_xor_b32 v143, s1, v9
    v_lshl_add_u32 v141, v143, 4, v141
    s_add_u32 s68, s22, 2162688
    v_add_u32 v244, s68, v141
    v_xor_b32 v243, 16, v244
    s_lshl_b32 s1, s36, 2
    v_add_u32 v141, s1, v137
    v_xor_b32 v141, v141, v5
    v_lshlrev_b32 v141, 4, v141
    v_lshl_add_u32 v141, v138, 2, v141
    v_lshl_add_u32 v141, v142, 12, v141
    v_lshrrev_b32 v143, 1, v5
    v_lshl_add_u32 v141, v143, 10, v141
    v_add_u32 v245, 81920, v141
    v_xor_b32 v246, 32, v245
    v_mul_u32_u24 v141, 272, v139
    v_lshl_add_u32 v141, v5, 5, v141
    s_mul_i32 s68, s36, 1088
    s_add_u32 s68, s68, 98304
    v_add_u32 v247, s68, v141
    s_waitcnt vmcnt(3)
    s_barrier
    s_movk_i32 s68, 256
    s_add_u32 m0, s71, 98304
    s_nop 0
    buffer_load_dwordx4 v124, s[56:59], s68 offen lds
    s_add_u32 m0, s71, 99328
    s_add_u32 s68, s68, 44032
    buffer_load_dwordx4 v124, s[56:59], s68 offen lds
    s_add_u32 m0, s71, 100352
    s_add_u32 s68, s68, 44032
    buffer_load_dwordx4 v124, s[56:59], s68 offen lds
    s_add_u32 m0, s71, 101376
    s_add_u32 s68, s68, 44032
    buffer_load_dwordx4 v124, s[56:59], s68 offen lds
    s_add_u32 m0, s71, 102400
    s_add_u32 s68, s68, 44032
    buffer_load_dwordx4 v124, s[56:59], s68 offen lds
    s_add_u32 m0, s71, 103424
    s_add_u32 s68, s68, 44032
    buffer_load_dwordx4 v124, s[56:59], s68 offen lds
    s_add_u32 m0, s71, 104448
    s_add_u32 s68, s68, 44032
    buffer_load_dwordx4 v124, s[56:59], s68 offen lds
    s_add_u32 m0, s71, 105472
    s_add_u32 s68, s68, 44032
    buffer_load_dwordx4 v124, s[56:59], s68 offen lds
    s_waitcnt vmcnt(9)
    s_mov_b64 exec, 1
    buffer_store_dword v249, off, s[40:43], s35 sc1
    s_mov_b64 exec, -1
    buffer_load_dwordx4 v[112:115], v92, s[48:51], 0 offen
    buffer_load_dwordx4 v[116:119], v92, s[48:51], 0 offen offset:1024
    s_barrier
    s_mov_b32 m0, 159744
    s_mov_b32 s68, 0x7f000000
    s_mov_b64 exec, 0xff
    buffer_load_dword v126, s[44:47], s68 offen lds
    s_mov_b64 exec, -1
    s_add_u32 m0, s69, 0
    s_add_u32 s68, s33, 0
    s_and_b32 s68, s68, 7
    s_mul_i32 s68, s68, 43
    s_add_u32 s68, s68, 3
    s_lshr_b32 s68, s68, 3
    s_lshl_b32 s68, s68, 15
    buffer_load_dwordx4 v126, s[44:47], s68 offen lds
    s_add_u32 m0, s69, 4096
    s_add_u32 s68, s68, 32768
    buffer_load_dwordx4 v126, s[44:47], s68 offen lds
    s_add_u32 m0, s69, 8192
    s_add_u32 s68, s33, 0
    s_and_b32 s68, s68, 7
    s_mul_i32 s68, s68, 43
    s_add_u32 s68, s68, 19
    s_lshr_b32 s68, s68, 3
    s_lshl_b32 s68, s68, 15
    buffer_load_dwordx4 v126, s[44:47], s68 offen lds
    s_add_u32 m0, s69, 12288
    s_add_u32 s68, s68, 32768
    buffer_load_dwordx4 v126, s[44:47], s68 offen lds
    s_waitcnt vmcnt(8)
    s_barrier
L_h_join:
    s_add_u32 m0, s69, 16384
    s_xor_b32 s68, s33, 1
    s_mul_i32 s68, s68, 43
    s_add_u32 s68, s68, 3
    s_lshr_b32 s68, s68, 3
    s_lshl_b32 s68, s68, 15
    buffer_load_dwordx4 v126, s[44:47], s68 offen lds
    s_load_dwordx8 s[4:11], s[30:31], s26 glc
    s_add_u32 m0, s69, 20480
    s_add_u32 s68, s68, 32768
    buffer_load_dwordx4 v126, s[44:47], s68 offen lds
    s_add_u32 m0, s69, 24576
    s_xor_b32 s68, s33, 2
    s_mul_i32 s68, s68, 43
    s_add_u32 s68, s68, 3
    s_lshr_b32 s68, s68, 3
    s_lshl_b32 s68, s68, 15
    buffer_load_dwordx4 v126, s[44:47], s68 offen lds
    s_add_u32 m0, s69, 28672
    s_add_u32 s68, s68, 32768
    buffer_load_dwordx4 v126, s[44:47], s68 offen lds
    s_add_u32 m0, s69, 139264
    s_xor_b32 s68, s33, 3
    s_mul_i32 s68, s68, 43
    s_add_u32 s68, s68, 3
    s_lshr_b32 s68, s68, 3
    s_lshl_b32 s68, s68, 15
    buffer_load_dwordx4 v126, s[44:47], s68 offen lds
    s_add_u32 m0, s69, 143360
    s_add_u32 s68, s68, 32768
    buffer_load_dwordx4 v126, s[44:47], s68 offen lds
    s_add_u32 m0, s69, 147456
    s_xor_b32 s68, s33, 4
    s_mul_i32 s68, s68, 43
    s_add_u32 s68, s68, 3
    s_lshr_b32 s68, s68, 3
    s_lshl_b32 s68, s68, 15
    buffer_load_dwordx4 v126, s[44:47], s68 offen lds
    s_add_u32 m0, s69, 151552
    s_add_u32 s68, s68, 32768
    buffer_load_dwordx4 v126, s[44:47], s68 offen lds
    s_add_u32 m0, s69, 131072
    s_xor_b32 s68, s33, 5
    s_mul_i32 s68, s68, 43
    s_add_u32 s68, s68, 3
    s_lshr_b32 s68, s68, 3
    s_lshl_b32 s68, s68, 15
    buffer_load_dwordx4 v126, s[44:47], s68 offen lds
    s_add_u32 m0, s69, 135168
    s_add_u32 s68, s68, 32768
    buffer_load_dwordx4 v126, s[44:47], s68 offen lds
    s_waitcnt lgkmcnt(0)
    s_xor_b64 s[4:5], s[4:5], s[28:29]
    s_xor_b64 s[6:7], s[6:7], s[28:29]
    s_xor_b64 s[8:9], s[8:9], s[28:29]
    s_xor_b64 s[10:11], s[10:11], s[28:29]
    s_or_b64 s[4:5], s[4:5], s[6:7]
    s_or_b64 s[4:5], s[4:5], s[8:9]
    s_or_b64 s[4:5], s[4:5], s[10:11]
    s_cbranch_scc1 L_gpT
L_gpdT:
    buffer_load_dwordx4 v[32:35], v128, s[40:43], 0 offen sc1
    buffer_load_dwordx4 v[36:39], v128, s[40:43], 0 offen offset:1024 sc1
    s_mov_b32 s1, 32768
    buffer_load_dwordx4 v[100:103], v123, s[60:63], 0 offen
    buffer_load_dwordx4 v[104:107], v123, s[60:63], s1 offen
    s_setprio 2
    s_waitcnt vmcnt(19)
    v_readlane_b32 s1, v115, 63
    v_mov_b32_dpp v120, v115 wave_shr:1 row_mask:0xf bank_mask:0xf
    s_nop 0
    v_mov_b32 v121, s1
    s_nop 1
    v_mov_b32_dpp v121, v119 wave_shr:1 row_mask:0xf bank_mask:0xf
    v_alignbit_b32 v20, v112, v120, 16
    v_alignbit_b32 v21, v113, v112, 16
    v_alignbit_b32 v22, v114, v113, 16
    v_alignbit_b32 v23, v115, v114, 16
    v_alignbit_b32 v24, v116, v121, 16
    v_alignbit_b32 v25, v117, v116, 16
    v_alignbit_b32 v26, v118, v117, 16
    v_alignbit_b32 v27, v119, v118, 16
    s_setprio 0
    s_barrier
    ds_write_b128 v237, v[112:115] offset:32
    ds_write_b128 v237, v[116:119] offset:1056
    ds_write_b128 v237, v[20:23] offset:4192
    ds_write_b128 v237, v[24:27] offset:5216
    s_mov_b32 exec_hi, 0
    ds_write_b128 v239, v[12:15]
    s_mov_b64 exec, 3
    ds_write_b128 v238, v[12:15]
    ds_write_b128 v238, v[12:15] offset:4160
    s_mov_b64 exec, -1
    s_waitcnt vmcnt(2)
    ds_write_b128 v129, v[32:35]
    ds_write_b128 v129, v[36:39] offset:512
    s_waitcnt lgkmcnt(0)
    s_setprio 2
    s_barrier
    ds_read_b128 v[200:203], v236 offset:192
    ds_read_b128 v[204:207], v236 offset:704
    ds_read_b128 v[208:211], v236 offset:1216
    ds_read_b128 v[212:215], v236 offset:1728
    ds_read_b128 v[216:219], v236 offset:2240
    ds_read_b128 v[220:223], v236 offset:2752
    ds_read_b128 v[224:227], v236 offset:3264
    ds_read_b128 v[228:231], v236 offset:3776
    ds_read2_b32 v[168:169], v232 offset0:0 offset1:1
    ds_read2_b32 v[170:171], v232 offset0:2 offset1:3
    ds_read2_b32 v[172:173], v232 offset0:128 offset1:129
    ds_read2_b32 v[174:175], v232 offset0:130 offset1:131
    s_waitcnt lgkmcnt(11)
    v_mfma_f32_16x16x32_bf16 v[136:139], v[252:255], v[200:203], 0
    ds_read2_b32 v[176:177], v233 offset0:0 offset1:1
    s_waitcnt lgkmcnt(11)
    v_mfma_f32_16x16x32_bf16 v[140:143], v[252:255], v[204:207], 0
    ds_read2_b32 v[178:179], v233 offset0:2 offset1:3
    s_waitcnt lgkmcnt(11)
    v_mfma_f32_16x16x32_bf16 v[144:147], v[252:255], v[208:211], 0
    ds_read2_b32 v[180:181], v233 offset0:128 offset1:129
    s_waitcnt lgkmcnt(11)
    v_mfma_f32_16x16x32_bf16 v[148:151], v[252:255], v[212:215], 0
    ds_read2_b32 v[182:183], v233 offset0:130 offset1:131
    s_waitcnt lgkmcnt(11)
    v_mfma_f32_16x16x32_bf16 v[152:155], v[252:255], v[216:219], 0
    ds_read2_b32 v[184:185], v234 offset0:0 offset1:1
    s_waitcnt lgkmcnt(11)
    v_mfma_f32_16x16x32_bf16 v[156:159], v[252:255], v[220:223], 0
    ds_read2_b32 v[186:187], v234 offset0:2 offset1:3
    s_waitcnt lgkmcnt(11)
    v_mfma_f32_16x16x32_bf16 v[160:163], v[252:255], v[224:227], 0
    ds_read2_b32 v[188:189], v234 offset0:128 offset1:129
    s_waitcnt lgkmcnt(11)
    v_mfma_f32_16x16x32_bf16 v[164:167], v[252:255], v[228:231], 0
    ds_read2_b32 v[190:191], v234 offset0:130 offset1:131
    s_waitcnt lgkmcnt(10)
    v_mfma_f32_16x16x32_bf16 v[136:139], v[168:171], v[200:203], v[136:139]
    ds_read2_b32 v[192:193], v235 offset0:0 offset1:1
    v_mfma_f32_16x16x32_bf16 v[140:143], v[168:171], v[204:207], v[140:143]
    ds_read2_b32 v[194:195], v235 offset0:2 offset1:3
    v_mfma_f32_16x16x32_bf16 v[144:147], v[168:171], v[208:211], v[144:147]
    ds_read2_b32 v[196:197], v235 offset0:128 offset1:129
    v_mfma_f32_16x16x32_bf16 v[148:151], v[168:171], v[212:215], v[148:151]
    ds_read2_b32 v[198:199], v235 offset0:130 offset1:131
    v_mfma_f32_16x16x32_bf16 v[152:155], v[168:171], v[216:219], v[152:155]
    ds_read_b128 v[64:67], v236 offset:128
    v_mfma_f32_16x16x32_bf16 v[156:159], v[168:171], v[220:223], v[156:159]
    ds_read2_b32 v[32:33], v232 offset0:16 offset1:17
    v_mfma_f32_16x16x32_bf16 v[160:163], v[168:171], v[224:227], v[160:163]
    ds_read2_b32 v[34:35], v232 offset0:18 offset1:19
    v_mfma_f32_16x16x32_bf16 v[164:167], v[168:171], v[228:231], v[164:167]
    ds_read_b128 v[68:71], v236 offset:640
    s_waitcnt lgkmcnt(15)
    v_mfma_f32_16x16x32_bf16 v[140:143], v[172:175], v[200:203], v[140:143]
    ds_read_b128 v[72:75], v236 offset:1152
    v_mfma_f32_16x16x32_bf16 v[144:147], v[172:175], v[204:207], v[144:147]
    ds_read_b128 v[76:79], v236 offset:1664
    v_mfma_f32_16x16x32_bf16 v[148:151], v[172:175], v[208:211], v[148:151]
    ds_read_b128 v[80:83], v236 offset:2176
    v_mfma_f32_16x16x32_bf16 v[152:155], v[172:175], v[212:215], v[152:155]
    ds_read_b128 v[84:87], v236 offset:2688
    v_mfma_f32_16x16x32_bf16 v[156:159], v[172:175], v[216:219], v[156:159]
    ds_read_b128 v[88:91], v236 offset:3200
    v_mfma_f32_16x16x32_bf16 v[160:163], v[172:175], v[220:223], v[160:163]
    ds_read_b128 v[92:95], v236 offset:3712
    v_mfma_f32_16x16x32_bf16 v[164:167], v[172:175], v[224:227], v[164:167]
    ds_read2_b32 v[36:37], v232 offset0:144 offset1:145
    s_waitcnt lgkmcnt(15)
    v_mfma_f32_16x16x32_bf16 v[144:147], v[176:179], v[200:203], v[144:147]
    ds_read2_b32 v[38:39], v232 offset0:146 offset1:147
    v_mfma_f32_16x16x32_bf16 v[148:151], v[176:179], v[204:207], v[148:151]
    ds_read2_b32 v[40:41], v233 offset0:16 offset1:17
    v_mfma_f32_16x16x32_bf16 v[152:155], v[176:179], v[208:211], v[152:155]
    ds_read2_b32 v[42:43], v233 offset0:18 offset1:19
    v_mfma_f32_16x16x32_bf16 v[156:159], v[176:179], v[212:215], v[156:159]
    ds_read2_b32 v[44:45], v233 offset0:144 offset1:145
    v_mfma_f32_16x16x32_bf16 v[160:163], v[176:179], v[216:219], v[160:163]
    ds_read2_b32 v[46:47], v233 offset0:146 offset1:147
    v_mfma_f32_16x16x32_bf16 v[164:167], v[176:179], v[220:223], v[164:167]
    ds_read2_b32 v[48:49], v234 offset0:16 offset1:17
    v_mfma_f32_16x16x32_bf16 v[148:151], v[180:183], v[200:203], v[148:151]
    ds_read2_b32 v[50:51], v234 offset0:18 offset1:19
    v_mfma_f32_16x16x32_bf16 v[152:155], v[180:183], v[204:207], v[152:155]
    ds_read2_b32 v[52:53], v234 offset0:144 offset1:145
    v_mfma_f32_16x16x32_bf16 v[156:159], v[180:183], v[208:211], v[156:159]
    ds_read2_b32 v[54:55], v234 offset0:146 offset1:147
    v_mfma_f32_16x16x32_bf16 v[160:163], v[180:183], v[212:215], v[160:163]
    ds_read2_b32 v[56:57], v235 offset0:16 offset1:17
    v_mfma_f32_16x16x32_bf16 v[164:167], v[180:183], v[216:219], v[164:167]
    ds_read2_b32 v[58:59], v235 offset0:18 offset1:19
    v_mfma_f32_16x16x32_bf16 v[152:155], v[184:187], v[200:203], v[152:155]
    ds_read2_b32 v[60:61], v235 offset0:144 offset1:145
    v_mfma_f32_16x16x32_bf16 v[156:159], v[184:187], v[204:207], v[156:159]
    ds_read2_b32 v[62:63], v235 offset0:146 offset1:147
    v_mfma_f32_16x16x32_bf16 v[160:163], v[184:187], v[208:211], v[160:163]
    v_mfma_f32_16x16x32_bf16 v[164:167], v[184:187], v[212:215], v[164:167]
    v_mfma_f32_16x16x32_bf16 v[156:159], v[188:191], v[200:203], v[156:159]
    v_mfma_f32_16x16x32_bf16 v[160:163], v[188:191], v[204:207], v[160:163]
    v_mfma_f32_16x16x32_bf16 v[164:167], v[188:191], v[208:211], v[164:167]
    s_waitcnt lgkmcnt(15)
    v_mfma_f32_16x16x32_bf16 v[160:163], v[192:195], v[200:203], v[160:163]
    v_mfma_f32_16x16x32_bf16 v[164:167], v[192:195], v[204:207], v[164:167]
    v_mfma_f32_16x16x32_bf16 v[164:167], v[196:199], v[200:203], v[164:167]
    v_mfma_f32_16x16x32_bf16 v[136:139], v[32:35], v[64:67], v[136:139]
    ds_read_b128 v[200:203], v236 offset:64
    v_mfma_f32_16x16x32_bf16 v[140:143], v[32:35], v[68:71], v[140:143]
    ds_read2_b32 v[168:169], v232 offset0:32 offset1:33
    v_mfma_f32_16x16x32_bf16 v[144:147], v[32:35], v[72:75], v[144:147]
    ds_read2_b32 v[170:171], v232 offset0:34 offset1:35
    v_mfma_f32_16x16x32_bf16 v[148:151], v[32:35], v[76:79], v[148:151]
    ds_read_b128 v[204:207], v236 offset:576
    v_mfma_f32_16x16x32_bf16 v[152:155], v[32:35], v[80:83], v[152:155]
    ds_read_b128 v[208:211], v236 offset:1088
    v_mfma_f32_16x16x32_bf16 v[156:159], v[32:35], v[84:87], v[156:159]
    ds_read_b128 v[212:215], v236 offset:1600
    v_mfma_f32_16x16x32_bf16 v[160:163], v[32:35], v[88:91], v[160:163]
    ds_read_b128 v[216:219], v236 offset:2112
    s_waitcnt lgkmcnt(15)
    v_mfma_f32_16x16x32_bf16 v[164:167], v[32:35], v[92:95], v[164:167]
    ds_read_b128 v[220:223], v236 offset:2624
    v_mfma_f32_16x16x32_bf16 v[140:143], v[36:39], v[64:67], v[140:143]
    ds_read_b128 v[224:227], v236 offset:3136
    v_mfma_f32_16x16x32_bf16 v[144:147], v[36:39], v[68:71], v[144:147]
    ds_read_b128 v[228:231], v236 offset:3648
    v_mfma_f32_16x16x32_bf16 v[148:151], v[36:39], v[72:75], v[148:151]
    ds_read2_b32 v[172:173], v232 offset0:160 offset1:161
    v_mfma_f32_16x16x32_bf16 v[152:155], v[36:39], v[76:79], v[152:155]
    ds_read2_b32 v[174:175], v232 offset0:162 offset1:163
    v_mfma_f32_16x16x32_bf16 v[156:159], v[36:39], v[80:83], v[156:159]
    ds_read2_b32 v[176:177], v233 offset0:32 offset1:33
    v_mfma_f32_16x16x32_bf16 v[160:163], v[36:39], v[84:87], v[160:163]
    ds_read2_b32 v[178:179], v233 offset0:34 offset1:35
    v_mfma_f32_16x16x32_bf16 v[164:167], v[36:39], v[88:91], v[164:167]
    ds_read2_b32 v[180:181], v233 offset0:160 offset1:161
    v_mfma_f32_16x16x32_bf16 v[144:147], v[40:43], v[64:67], v[144:147]
    ds_read2_b32 v[182:183], v233 offset0:162 offset1:163
    v_mfma_f32_16x16x32_bf16 v[148:151], v[40:43], v[68:71], v[148:151]
    ds_read2_b32 v[184:185], v234 offset0:32 offset1:33
    v_mfma_f32_16x16x32_bf16 v[152:155], v[40:43], v[72:75], v[152:155]
    ds_read2_b32 v[186:187], v234 offset0:34 offset1:35
    v_mfma_f32_16x16x32_bf16 v[156:159], v[40:43], v[76:79], v[156:159]
    ds_read2_b32 v[188:189], v234 offset0:160 offset1:161
    v_mfma_f32_16x16x32_bf16 v[160:163], v[40:43], v[80:83], v[160:163]
    ds_read2_b32 v[190:191], v234 offset0:162 offset1:163
    v_mfma_f32_16x16x32_bf16 v[164:167], v[40:43], v[84:87], v[164:167]
    ds_read2_b32 v[192:193], v235 offset0:32 offset1:33
    v_mfma_f32_16x16x32_bf16 v[148:151], v[44:47], v[64:67], v[148:151]
    ds_read2_b32 v[194:195], v235 offset0:34 offset1:35
    v_mfma_f32_16x16x32_bf16 v[152:155], v[44:47], v[68:71], v[152:155]
    ds_read2_b32 v[196:197], v235 offset0:160 offset1:161
    v_mfma_f32_16x16x32_bf16 v[156:159], v[44:47], v[72:75], v[156:159]
    ds_read2_b32 v[198:199], v235 offset0:162 offset1:163
    v_mfma_f32_16x16x32_bf16 v[160:163], v[44:47], v[76:79], v[160:163]
    v_mfma_f32_16x16x32_bf16 v[164:167], v[44:47], v[80:83], v[164:167]
    s_waitcnt lgkmcnt(15)
    v_mfma_f32_16x16x32_bf16 v[152:155], v[48:51], v[64:67], v[152:155]
    v_mfma_f32_16x16x32_bf16 v[156:159], v[48:51], v[68:71], v[156:159]
    v_mfma_f32_16x16x32_bf16 v[160:163], v[48:51], v[72:75], v[160:163]
    v_mfma_f32_16x16x32_bf16 v[164:167], v[48:51], v[76:79], v[164:167]
    v_mfma_f32_16x16x32_bf16 v[156:159], v[52:55], v[64:67], v[156:159]
    v_mfma_f32_16x16x32_bf16 v[160:163], v[52:55], v[68:71], v[160:163]
    v_mfma_f32_16x16x32_bf16 v[164:167], v[52:55], v[72:75], v[164:167]
    v_mfma_f32_16x16x32_bf16 v[160:163], v[56:59], v[64:67], v[160:163]
    v_mfma_f32_16x16x32_bf16 v[164:167], v[56:59], v[68:71], v[164:167]
    v_mfma_f32_16x16x32_bf16 v[164:167], v[60:63], v[64:67], v[164:167]
    v_mfma_f32_16x16x32_bf16 v[136:139], v[168:171], v[200:203], v[136:139]
    ds_read_b128 v[64:67], v236 offset:0
    v_mfma_f32_16x16x32_bf16 v[140:143], v[168:171], v[204:207], v[140:143]
    ds_read2_b32 v[32:33], v232 offset0:48 offset1:49
    v_mfma_f32_16x16x32_bf16 v[144:147], v[168:171], v[208:211], v[144:147]
    ds_read2_b32 v[34:35], v232 offset0:50 offset1:51
    v_mfma_f32_16x16x32_bf16 v[148:151], v[168:171], v[212:215], v[148:151]
    ds_read_b128 v[68:71], v236 offset:512
    v_mfma_f32_16x16x32_bf16 v[152:155], v[168:171], v[216:219], v[152:155]
    ds_read_b128 v[72:75], v236 offset:1024
    v_mfma_f32_16x16x32_bf16 v[156:159], v[168:171], v[220:223], v[156:159]
    ds_read_b128 v[76:79], v236 offset:1536
    v_mfma_f32_16x16x32_bf16 v[160:163], v[168:171], v[224:227], v[160:163]
    ds_read_b128 v[80:83], v236 offset:2048
    s_waitcnt lgkmcnt(15)
    v_mfma_f32_16x16x32_bf16 v[164:167], v[168:171], v[228:231], v[164:167]
    ds_read_b128 v[84:87], v236 offset:2560
    v_mfma_f32_16x16x32_bf16 v[140:143], v[172:175], v[200:203], v[140:143]
    ds_read_b128 v[88:91], v236 offset:3072
    v_mfma_f32_16x16x32_bf16 v[144:147], v[172:175], v[204:207], v[144:147]
    ds_read_b128 v[92:95], v236 offset:3584
    v_mfma_f32_16x16x32_bf16 v[148:151], v[172:175], v[208:211], v[148:151]
    ds_read2_b32 v[36:37], v232 offset0:176 offset1:177
    v_mfma_f32_16x16x32_bf16 v[152:155], v[172:175], v[212:215], v[152:155]
    ds_read2_b32 v[38:39], v232 offset0:178 offset1:179
    v_mfma_f32_16x16x32_bf16 v[156:159], v[172:175], v[216:219], v[156:159]
    ds_read2_b32 v[40:41], v233 offset0:48 offset1:49
    v_mfma_f32_16x16x32_bf16 v[160:163], v[172:175], v[220:223], v[160:163]
    ds_read2_b32 v[42:43], v233 offset0:50 offset1:51
    v_mfma_f32_16x16x32_bf16 v[164:167], v[172:175], v[224:227], v[164:167]
    ds_read2_b32 v[44:45], v233 offset0:176 offset1:177
    v_mfma_f32_16x16x32_bf16 v[144:147], v[176:179], v[200:203], v[144:147]
    ds_read2_b32 v[46:47], v233 offset0:178 offset1:179
    v_mfma_f32_16x16x32_bf16 v[148:151], v[176:179], v[204:207], v[148:151]
    ds_read2_b32 v[48:49], v234 offset0:48 offset1:49
    v_mfma_f32_16x16x32_bf16 v[152:155], v[176:179], v[208:211], v[152:155]
    ds_read2_b32 v[50:51], v234 offset0:50 offset1:51
    v_mfma_f32_16x16x32_bf16 v[156:159], v[176:179], v[212:215], v[156:159]
    ds_read2_b32 v[52:53], v234 offset0:176 offset1:177
    v_mfma_f32_16x16x32_bf16 v[160:163], v[176:179], v[216:219], v[160:163]
    ds_read2_b32 v[54:55], v234 offset0:178 offset1:179
    v_mfma_f32_16x16x32_bf16 v[164:167], v[176:179], v[220:223], v[164:167]
    ds_read2_b32 v[56:57], v235 offset0:48 offset1:49
    v_mfma_f32_16x16x32_bf16 v[148:151], v[180:183], v[200:203], v[148:151]
    ds_read2_b32 v[58:59], v235 offset0:50 offset1:51
    v_mfma_f32_16x16x32_bf16 v[152:155], v[180:183], v[204:207], v[152:155]
    ds_read2_b32 v[60:61], v235 offset0:176 offset1:177
    v_mfma_f32_16x16x32_bf16 v[156:159], v[180:183], v[208:211], v[156:159]
    ds_read2_b32 v[62:63], v235 offset0:178 offset1:179
    s_mov_b64 exec, 1
    ds_add_u32 v127, v1 offset:0
    s_mov_b64 exec, -1
    v_mfma_f32_16x16x32_bf16 v[160:163], v[180:183], v[212:215], v[160:163]
    v_mfma_f32_16x16x32_bf16 v[164:167], v[180:183], v[216:219], v[164:167]
    s_waitcnt lgkmcnt(15)
    v_mfma_f32_16x16x32_bf16 v[152:155], v[184:187], v[200:203], v[152:155]
    v_mfma_f32_16x16x32_bf16 v[156:159], v[184:187], v[204:207], v[156:159]
    v_mfma_f32_16x16x32_bf16 v[160:163], v[184:187], v[208:211], v[160:163]
    v_mfma_f32_16x16x32_bf16 v[164:167], v[184:187], v[212:215], v[164:167]
    v_mfma_f32_16x16x32_bf16 v[156:159], v[188:191], v[200:203], v[156:159]
    v_mfma_f32_16x16x32_bf16 v[160:163], v[188:191], v[204:207], v[160:163]
    v_mfma_f32_16x16x32_bf16 v[164:167], v[188:191], v[208:211], v[164:167]
    v_mfma_f32_16x16x32_bf16 v[160:163], v[192:195], v[200:203], v[160:163]
    v_mfma_f32_16x16x32_bf16 v[164:167], v[192:195], v[204:207], v[164:167]
    v_mfma_f32_16x16x32_bf16 v[164:167], v[196:199], v[200:203], v[164:167]
    v_mfma_f32_16x16x32_bf16 v[136:139], v[32:35], v[64:67], v[136:139]
    v_mfma_f32_16x16x32_bf16 v[140:143], v[32:35], v[68:71], v[140:143]
    s_waitcnt lgkmcnt(13)
    v_mfma_f32_16x16x32_bf16 v[140:143], v[36:39], v[64:67], v[140:143]
    v_mfma_f32_16x16x32_bf16 v[144:147], v[32:35], v[72:75], v[144:147]
    v_mfma_f32_16x16x32_bf16 v[144:147], v[36:39], v[68:71], v[144:147]
    s_waitcnt lgkmcnt(11)
    v_mfma_f32_16x16x32_bf16 v[144:147], v[40:43], v[64:67], v[144:147]
    v_mfma_f32_16x16x32_bf16 v[148:151], v[32:35], v[76:79], v[148:151]
    v_mfma_f32_16x16x32_bf16 v[148:151], v[36:39], v[72:75], v[148:151]
    v_mfma_f32_16x16x32_bf16 v[148:151], v[40:43], v[68:71], v[148:151]
    s_waitcnt lgkmcnt(9)
    v_mfma_f32_16x16x32_bf16 v[148:151], v[44:47], v[64:67], v[148:151]
    ds_read_b32 v18, v127 offset:0
    v_mfma_f32_16x16x32_bf16 v[152:155], v[32:35], v[80:83], v[152:155]
    v_mfma_f32_16x16x32_bf16 v[152:155], v[36:39], v[76:79], v[152:155]
    v_mfma_f32_16x16x32_bf16 v[152:155], v[40:43], v[72:75], v[152:155]
    v_mfma_f32_16x16x32_bf16 v[152:155], v[44:47], v[68:71], v[152:155]
    s_waitcnt lgkmcnt(8)
    v_mfma_f32_16x16x32_bf16 v[152:155], v[48:51], v[64:67], v[152:155]
    s_waitcnt lgkmcnt(0)
    v_cmp_gt_u32 vcc, 4, v18
    s_nop 1
    s_cbranch_vccnz L_spR1
L_spdR1:
    ds_write_b128 v240, v[136:139] offset:0
    v_mfma_f32_16x16x32_bf16 v[156:159], v[32:35], v[84:87], v[156:159]
    v_mfma_f32_16x16x32_bf16 v[156:159], v[36:39], v[80:83], v[156:159]
    v_mfma_f32_16x16x32_bf16 v[156:159], v[40:43], v[76:79], v[156:159]
    ds_write_b128 v240, v[140:143] offset:4096
    v_mfma_f32_16x16x32_bf16 v[156:159], v[44:47], v[72:75], v[156:159]
    v_mfma_f32_16x16x32_bf16 v[156:159], v[48:51], v[68:71], v[156:159]
    v_mfma_f32_16x16x32_bf16 v[156:159], v[52:55], v[64:67], v[156:159]
    ds_write_b128 v240, v[144:147] offset:1024
    v_mfma_f32_16x16x32_bf16 v[160:163], v[32:35], v[88:91], v[160:163]
    v_mfma_f32_16x16x32_bf16 v[160:163], v[36:39], v[84:87], v[160:163]
    v_mfma_f32_16x16x32_bf16 v[160:163], v[40:43], v[80:83], v[160:163]
    ds_write_b128 v240, v[148:151] offset:5120
    v_mfma_f32_16x16x32_bf16 v[160:163], v[44:47], v[76:79], v[160:163]
    v_mfma_f32_16x16x32_bf16 v[160:163], v[48:51], v[72:75], v[160:163]
    v_mfma_f32_16x16x32_bf16 v[160:163], v[52:55], v[68:71], v[160:163]
    ds_write_b128 v240, v[152:155] offset:2048
    v_mfma_f32_16x16x32_bf16 v[160:163], v[56:59], v[64:67], v[160:163]
    v_mfma_f32_16x16x32_bf16 v[164:167], v[32:35], v[92:95], v[164:167]
    v_mfma_f32_16x16x32_bf16 v[164:167], v[36:39], v[88:91], v[164:167]
    ds_write_b128 v240, v[156:159] offset:6144
    v_mfma_f32_16x16x32_bf16 v[164:167], v[40:43], v[84:87], v[164:167]
    v_mfma_f32_16x16x32_bf16 v[164:167], v[44:47], v[80:83], v[164:167]
    v_mfma_f32_16x16x32_bf16 v[164:167], v[48:51], v[76:79], v[164:167]
    s_nop 1
    ds_write_b128 v240, v[160:163] offset:3072
    v_mfma_f32_16x16x32_bf16 v[164:167], v[52:55], v[72:75], v[164:167]
    v_mfma_f32_16x16x32_bf16 v[164:167], v[56:59], v[68:71], v[164:167]
    v_mfma_f32_16x16x32_bf16 v[164:167], v[60:63], v[64:67], v[164:167]
    s_nop 7
    ds_write_b128 v240, v[164:167] offset:7168
    s_mov_b64 exec, 1
    ds_add_u32 v127, v1 offset:4
    s_mov_b64 exec, -1
    s_setprio 2
    s_waitcnt vmcnt(0)
    ds_read_b32 v18, v127 offset:4
    s_waitcnt lgkmcnt(0)
    v_cmp_gt_u32 vcc, 4, v18
    s_nop 1
    s_cbranch_vccnz L_spR2
L_spdR2:
    ds_read_b128 v[32:35], v241 offset:0
    ds_read_b128 v[40:43], v241 offset:8192
    ds_read_b128 v[48:51], v241 offset:16384
    ds_read_b128 v[56:59], v241 offset:24576
    ds_read_b128 v[36:39], v241 offset:4096
    ds_read_b128 v[44:47], v241 offset:12288
    ds_read_b128 v[52:55], v241 offset:20480
    ds_read_b128 v[60:63], v241 offset:28672
    s_waitcnt lgkmcnt(4)
    v_add_f32 v32, v32, v40
    v_add_f32 v48, v48, v56
    v_add_f32 v33, v33, v41
    v_add_f32 v49, v49, v57
    v_add_f32 v34, v34, v42
    v_add_f32 v50, v50, v58
    v_add_f32 v35, v35, v43
    v_add_f32 v51, v51, v59
    v_cvt_pk_bf16_f32 v64, v32, v48
    v_cvt_pk_bf16_f32 v65, v33, v49
    v_cvt_pk_bf16_f32 v66, v34, v50
    v_cvt_pk_bf16_f32 v67, v35, v51
    buffer_store_dwordx4 v[64:67], v242, s[40:43], 0 offen offset:0 sc1
    s_waitcnt lgkmcnt(0)
    v_add_f32 v36, v36, v44
    v_add_f32 v52, v52, v60
    v_add_f32 v37, v37, v45
    v_add_f32 v53, v53, v61
    v_add_f32 v38, v38, v46
    v_add_f32 v54, v54, v62
    v_add_f32 v39, v39, v47
    v_add_f32 v55, v55, v63
    v_cvt_pk_bf16_f32 v68, v36, v52
    v_cvt_pk_bf16_f32 v69, v37, v53
    v_cvt_pk_bf16_f32 v70, v38, v54
    v_cvt_pk_bf16_f32 v71, v39, v55
    buffer_store_dwordx4 v[68:71], v242, s[40:43], 0 offen offset:1024 sc1
    s_setprio 2
    v_cvt_pk_bf16_f32 v96, v96, v96
    v_cvt_pk_bf16_f32 v98, v98, v98
    v_and_b32 v96, 0xffff0000, v96
    v_and_b32 v98, 0xffff0000, v98
    v_mul_f32 v97, 0x3b000000, v97
    v_mul_f32 v99, 0x3b000000, v99
    v_cvt_pk_bf16_f32 v97, v97, v97
    v_cvt_pk_bf16_f32 v99, v99, v99
    v_and_b32 v97, 0xffff0000, v97
    v_and_b32 v99, 0xffff0000, v99
    v_add_f32 v97, 0x3727c5ac, v97
    v_add_f32 v99, 0x3727c5ac, v99
    v_cvt_pk_bf16_f32 v97, v97, v97
    v_cvt_pk_bf16_f32 v99, v99, v99
    v_and_b32 v97, 0xffff0000, v97
    v_and_b32 v99, 0xffff0000, v99
    v_sqrt_f32 v97, v97
    v_sqrt_f32 v99, v99
    v_cvt_pk_bf16_f32 v97, v97, v97
    v_cvt_pk_bf16_f32 v99, v99, v99
    v_and_b32 v97, 0xffff0000, v97
    v_and_b32 v99, 0xffff0000, v99
    v_rcp_f32 v97, v97
    v_rcp_f32 v99, v99
    v_lshlrev_b32 v19, 16, v108
    v_lshlrev_b32 v2, 16, v100
    v_add_f32 v20, v2, v96
    v_mul_f32 v20, v20, v97
    v_add_f32 v2, v2, v19
    v_lshlrev_b32 v10, 16, v104
    v_add_f32 v28, v10, v98
    v_mul_f32 v28, v28, v99
    v_add_f32 v10, v10, v19
    v_and_b32 v19, 0xffff0000, v108
    v_and_b32 v3, 0xffff0000, v100
    v_add_f32 v21, v3, v96
    v_mul_f32 v21, v21, v97
    v_add_f32 v3, v3, v19
    v_and_b32 v11, 0xffff0000, v104
    v_add_f32 v29, v11, v98
    v_mul_f32 v29, v29, v99
    v_add_f32 v11, v11, v19
    v_lshlrev_b32 v19, 16, v109
    v_lshlrev_b32 v4, 16, v101
    v_add_f32 v22, v4, v96
    v_mul_f32 v22, v22, v97
    v_add_f32 v4, v4, v19
    v_lshlrev_b32 v12, 16, v105
    v_add_f32 v30, v12, v98
    v_mul_f32 v30, v30, v99
    v_add_f32 v12, v12, v19
    v_and_b32 v19, 0xffff0000, v109
    v_and_b32 v5, 0xffff0000, v101
    v_add_f32 v23, v5, v96
    v_mul_f32 v23, v23, v97
    v_add_f32 v5, v5, v19
    v_and_b32 v13, 0xffff0000, v105
    v_add_f32 v31, v13, v98
    v_mul_f32 v31, v31, v99
    v_add_f32 v13, v13, v19
    v_lshlrev_b32 v19, 16, v110
    v_lshlrev_b32 v6, 16, v102
    v_add_f32 v24, v6, v96
    v_mul_f32 v24, v24, v97
    v_add_f32 v6, v6, v19
    v_lshlrev_b32 v14, 16, v106
    v_add_f32 v112, v14, v98
    v_mul_f32 v112, v112, v99
    v_add_f32 v14, v14, v19
    v_and_b32 v19, 0xffff0000, v110
    v_and_b32 v7, 0xffff0000, v102
    v_add_f32 v25, v7, v96
    v_mul_f32 v25, v25, v97
    v_add_f32 v7, v7, v19
    v_and_b32 v15, 0xffff0000, v106
    v_add_f32 v113, v15, v98
    v_mul_f32 v113, v113, v99
    v_add_f32 v15, v15, v19
    v_lshlrev_b32 v19, 16, v111
    v_lshlrev_b32 v8, 16, v103
    v_add_f32 v26, v8, v96
    v_mul_f32 v26, v26, v97
    v_add_f32 v8, v8, v19
    v_lshlrev_b32 v16, 16, v107
    v_add_f32 v114, v16, v98
    v_mul_f32 v114, v114, v99
    v_add_f32 v16, v16, v19
    v_and_b32 v19, 0xffff0000, v111
    v_and_b32 v9, 0xffff0000, v103
    v_add_f32 v27, v9, v96
    v_mul_f32 v27, v27, v97
    v_add_f32 v9, v9, v19
    v_and_b32 v17, 0xffff0000, v107
    v_add_f32 v115, v17, v98
    v_mul_f32 v115, v115, v99
    v_add_f32 v17, v17, v19
    s_setprio 2
    s_waitcnt vmcnt(0)
    s_mov_b64 exec, 1
    s_add_u32 s68, s35, 128
    buffer_store_dword v249, off, s[40:43], s68 sc1
    s_mov_b64 exec, -1
    s_cmp_lg_u32 s27, 0x7f000000
    s_cbranch_scc1 L_bumpC
L_bumpCd:
    s_load_dwordx8 s[4:11], s[30:31], s70 glc
    s_waitcnt lgkmcnt(0)
    s_xor_b64 s[4:5], s[4:5], s[28:29]
    s_xor_b64 s[6:7], s[6:7], s[28:29]
    s_xor_b64 s[8:9], s[8:9], s[28:29]
    s_xor_b64 s[10:11], s[10:11], s[28:29]
    s_or_b64 s[4:5], s[4:5], s[6:7]
    s_or_b64 s[4:5], s[4:5], s[8:9]
    s_or_b64 s[4:5], s[4:5], s[10:11]
    s_cbranch_scc1 L_gpZ0
L_gpdZ0:
    s_add_u32 m0, s69, 81920
    s_mov_b32 s68, 33792
    buffer_load_dwordx4 v244, s[40:43], 0 offen sc1 lds
    s_add_u32 m0, s69, 86016
    s_nop 0
    buffer_load_dwordx4 v243, s[40:43], s68 offen sc1 lds
    s_waitcnt vmcnt(0)
    s_mov_b64 exec, 1
    ds_add_u32 v127, v1 offset:20
    s_mov_b64 exec, -1
    ds_read_b32 v18, v127 offset:20
    s_waitcnt lgkmcnt(0)
    v_cmp_gt_u32 vcc, 4, v18
    s_nop 1
    s_cbranch_vccnz L_spZ
L_spdZ:
    ds_read_b32 v64, v245 offset:0
    ds_read_b32 v65, v245 offset:256
    ds_read_b32 v66, v245 offset:512
    ds_read_b32 v67, v245 offset:768
    ds_read_b32 v68, v246 offset:0
    ds_read_b32 v69, v246 offset:256
    ds_read_b32 v70, v246 offset:512
    ds_read_b32 v71, v246 offset:768
    s_mov_b32 s68, 32768
    s_waitcnt lgkmcnt(0)
    v_lshlrev_b32 v72, 16, v64
    v_and_b32 v73, 0xffff0000, v64
    v_lshlrev_b32 v74, 16, v65
    v_and_b32 v75, 0xffff0000, v65
    v_lshlrev_b32 v76, 16, v66
    v_and_b32 v77, 0xffff0000, v66
    v_lshlrev_b32 v78, 16, v67
    v_and_b32 v79, 0xffff0000, v67
    v_lshlrev_b32 v80, 16, v68
    v_and_b32 v81, 0xffff0000, v68
    v_lshlrev_b32 v82, 16, v69
    v_and_b32 v83, 0xffff0000, v69
    v_lshlrev_b32 v84, 16, v70
    v_and_b32 v85, 0xffff0000, v70
    v_lshlrev_b32 v86, 16, v71
    v_and_b32 v87, 0xffff0000, v71
    v_fmac_f32 v2, v20, v72
    v_fmac_f32 v3, v21, v73
    v_fmac_f32 v4, v22, v74
    v_fmac_f32 v5, v23, v75
    v_fmac_f32 v6, v24, v76
    v_fmac_f32 v7, v25, v77
    v_fmac_f32 v8, v26, v78
    v_fmac_f32 v9, v27, v79
    v_fmac_f32 v10, v28, v80
    v_fmac_f32 v11, v29, v81
    v_fmac_f32 v12, v30, v82
    v_fmac_f32 v13, v31, v83
    v_fmac_f32 v14, v112, v84
    v_fmac_f32 v15, v113, v85
    v_fmac_f32 v16, v114, v86
    v_fmac_f32 v17, v115, v87
    s_barrier
    ds_read_b128 v[64:67], v247 offset:0
    ds_read_b128 v[68:71], v247 offset:16
    ds_read_b128 v[72:75], v247 offset:17408
    ds_read_b128 v[76:79], v247 offset:17424
    ds_read_b128 v[80:83], v247 offset:8704
    ds_read_b128 v[84:87], v247 offset:8720
    ds_read_b128 v[88:91], v247 offset:26112
    ds_read_b128 v[92:95], v247 offset:26128
    s_waitcnt lgkmcnt(4)
    v_pk_add_f32 v[2:3], v[2:3], v[64:65]
    v_pk_add_f32 v[4:5], v[4:5], v[66:67]
    v_pk_add_f32 v[6:7], v[6:7], v[68:69]
    v_pk_add_f32 v[8:9], v[8:9], v[70:71]
    v_pk_add_f32 v[2:3], v[2:3], v[72:73]
    v_pk_add_f32 v[4:5], v[4:5], v[74:75]
    v_pk_add_f32 v[6:7], v[6:7], v[76:77]
    v_pk_add_f32 v[8:9], v[8:9], v[78:79]
    v_cvt_pk_bf16_f32 v32, v2, v3
    v_cvt_pk_bf16_f32 v33, v4, v5
    v_cvt_pk_bf16_f32 v34, v6, v7
    v_cvt_pk_bf16_f32 v35, v8, v9
    buffer_store_dwordx4 v[32:35], v123, s[64:67], 0 offen sc1
    s_waitcnt lgkmcnt(0)
    v_pk_add_f32 v[10:11], v[10:11], v[80:81]
    v_pk_add_f32 v[12:13], v[12:13], v[82:83]
    v_pk_add_f32 v[14:15], v[14:15], v[84:85]
    v_pk_add_f32 v[16:17], v[16:17], v[86:87]
    v_pk_add_f32 v[10:11], v[10:11], v[88:89]
    v_pk_add_f32 v[12:13], v[12:13], v[90:91]
    v_pk_add_f32 v[14:15], v[14:15], v[92:93]
    v_pk_add_f32 v[16:17], v[16:17], v[94:95]
    v_cvt_pk_bf16_f32 v36, v10, v11
    v_cvt_pk_bf16_f32 v37, v12, v13
    v_cvt_pk_bf16_f32 v38, v14, v15
    v_cvt_pk_bf16_f32 v39, v16, v17
    buffer_store_dwordx4 v[36:39], v123, s[64:67], s68 offen sc1
    s_endpgm
L_h_six:
    s_movk_i32 s68, 384
    s_mov_b32 exec_lo, 0xf0f0f0f
    s_mov_b32 exec_hi, 0xf0f0f0f
    s_add_u32 m0, s71, 65536
    s_nop 0
    buffer_load_dwordx4 v125, s[56:59], s68 offen lds
    s_add_u32 m0, s71, 66560
    s_add_u32 s68, s68, 44032
    buffer_load_dwordx4 v125, s[56:59], s68 offen lds
    s_waitcnt vmcnt(11)
    s_add_u32 m0, s71, 67584
    s_add_u32 s68, s68, 44032
    buffer_load_dwordx4 v125, s[56:59], s68 offen lds
    s_waitcnt vmcnt(11)
    s_add_u32 m0, s71, 68608
    s_add_u32 s68, s68, 44032
    buffer_load_dwordx4 v125, s[56:59], s68 offen lds
    s_waitcnt vmcnt(11)
    s_add_u32 m0, s71, 69632
    s_add_u32 s68, s68, 44032
    buffer_load_dwordx4 v125, s[56:59], s68 offen lds
    s_waitcnt vmcnt(11)
    s_add_u32 m0, s71, 70656
    s_add_u32 s68, s68, 44032
    buffer_load_dwordx4 v125, s[56:59], s68 offen lds
    s_waitcnt vmcnt(11)
    s_add_u32 m0, s71, 71680
    s_add_u32 s68, s68, 44032
    buffer_load_dwordx4 v125, s[56:59], s68 offen lds
    s_waitcnt vmcnt(11)
    s_add_u32 m0, s71, 72704
    s_add_u32 s68, s68, 44032
    buffer_load_dwordx4 v125, s[56:59], s68 offen lds
    s_mov_b64 exec, -1
    s_mov_b32 s1, 8448
    buffer_store_dwordx4 v[80:83], v18, s[40:43], 0 offen sc1
    buffer_store_dwordx4 v[84:87], v18, s[40:43], s1 offen sc1
    s_mul_i32 s68, s21, 8448
    s_lshl_b32 s1, s36, 11
    s_add_u32 s68, s68, s1
    v_add_u32 v128, s68, v250
    v_lshrrev_b32 v141, 2, v9
    v_lshlrev_b32 v141, 8, v141
    v_lshl_add_u32 v141, v136, 6, v141
    v_lshl_add_u32 v141, v140, 4, v141
    s_add_u32 s68, s68, 2162688
    v_add_u32 v242, s68, v141
    v_and_b32 v142, 1, v0
    v_mul_u32_u24 v129, 4608, v142
    v_lshrrev_b32 v141, 1, v0
    v_lshl_add_u32 v129, v141, 4, v129
    s_add_u32 s68, s69, 83712
    v_add_u32 v129, s68, v129
    s_mul_i32 s38, s20, 8320
    s_add_u32 s38, s38, 66560
    s_mul_i32 s39, s20, 4608
    s_add_u32 s39, s39, 83200
    s_lshl_b32 s68, s37, 11
    s_add_u32 s68, s68, s38
    v_add_u32 v237, s68, v250
    v_add_u32 v238, s38, v250
    v_add_u32 v239, s39, v250
    v_lshrrev_b32 v141, 1, v9
    v_lshl_add_u32 v141, v136, 2, v141
    v_lshlrev_b32 v141, 2, v141
    v_mul_u32_u24 v143, 4160, v142
    v_sub_u32 v141, v141, v143
    s_lshl_b32 s1, s37, 8
    s_add_u32 s68, s1, s38
    s_add_u32 s68, s68, 4164
    v_add_u32 v232, s68, v141
    v_add_u32 v233, 1024, v232
    v_add_u32 v234, 2048, v232
    v_add_u32 v235, 3072, v232
    v_lshlrev_b32 v141, 1, v9
    v_sub_u32 v141, v141, v136
    v_lshlrev_b32 v141, 4, v141
    s_sub_u32 s68, s39, s1
    s_add_u32 s68, s68, 336
    v_add_u32 v236, s68, v141
    s_add_u32 s68, s71, 65536
    v_add_u32 v240, s68, v250
    s_add_u32 s68, s69, 65536
    v_add_u32 v241, s68, v250
    v_mul_u32_u24 v141, 8448, v136
    s_lshl_b32 s1, s36, 1
    v_xor_b32 v143, s1, v9
    v_lshl_add_u32 v141, v143, 4, v141
    s_add_u32 s68, s22, 2162688
    v_add_u32 v244, s68, v141
    v_xor_b32 v243, 16, v244
    s_lshl_b32 s1, s36, 2
    v_add_u32 v141, s1, v137
    v_xor_b32 v141, v141, v5
    v_lshlrev_b32 v141, 4, v141
    v_lshl_add_u32 v141, v138, 2, v141
    v_lshl_add_u32 v141, v142, 12, v141
    v_lshrrev_b32 v143, 1, v5
    v_lshl_add_u32 v141, v143, 10, v141
    v_add_u32 v245, 81920, v141
    v_xor_b32 v246, 32, v245
    v_mul_u32_u24 v141, 272, v139
    v_lshl_add_u32 v141, v5, 5, v141
    s_mul_i32 s68, s36, 1088
    s_add_u32 s68, s68, 98304
    v_add_u32 v247, s68, v141
    s_waitcnt vmcnt(10)
    s_barrier
    s_movk_i32 s68, 256
    s_add_u32 m0, s71, 98304
    s_nop 0
    buffer_load_dwordx4 v124, s[56:59], s68 offen lds
    s_waitcnt vmcnt(10)
    s_add_u32 m0, s71, 99328
    s_add_u32 s68, s68, 44032
    buffer_load_dwordx4 v124, s[56:59], s68 offen lds
    s_waitcnt vmcnt(10)
    s_add_u32 m0, s71, 100352
    s_add_u32 s68, s68, 44032
    buffer_load_dwordx4 v124, s[56:59], s68 offen lds
    s_waitcnt vmcnt(10)
    s_add_u32 m0, s71, 101376
    s_add_u32 s68, s68, 44032
    buffer_load_dwordx4 v124, s[56:59], s68 offen lds
    s_waitcnt vmcnt(10)
    s_add_u32 m0, s71, 102400
    s_add_u32 s68, s68, 44032
    buffer_load_dwordx4 v124, s[56:59], s68 offen lds
    s_waitcnt vmcnt(10)
    s_add_u32 m0, s71, 103424
    s_add_u32 s68, s68, 44032
    buffer_load_dwordx4 v124, s[56:59], s68 offen lds
    s_waitcnt vmcnt(10)
    s_add_u32 m0, s71, 104448
    s_add_u32 s68, s68, 44032
    buffer_load_dwordx4 v124, s[56:59], s68 offen lds
    s_waitcnt vmcnt(10)
    s_add_u32 m0, s71, 105472
    s_add_u32 s68, s68, 44032
    buffer_load_dwordx4 v124, s[56:59], s68 offen lds
    s_waitcnt vmcnt(8)
    s_mov_b64 exec, 1
    buffer_store_dword v249, off, s[40:43], s35 sc1
    s_mov_b64 exec, -1
    buffer_load_dwordx4 v[112:115], v92, s[48:51], 0 offen
    buffer_load_dwordx4 v[116:119], v92, s[48:51], 0 offen offset:1024
    s_barrier
    s_mov_b32 m0, 159744
    s_mov_b32 s68, 0x7f000000
    s_mov_b64 exec, 0xff
    buffer_load_dword v126, s[44:47], s68 offen lds
    s_mov_b64 exec, -1
    s_add_u32 m0, s69, 0
    s_add_u32 s68, s33, 0
    s_and_b32 s68, s68, 7
    s_mul_i32 s68, s68, 43
    s_add_u32 s68, s68, 3
    s_lshr_b32 s68, s68, 3
    s_lshl_b32 s68, s68, 15
    buffer_load_dwordx4 v126, s[44:47], s68 offen lds
    s_add_u32 m0, s69, 4096
    s_add_u32 s68, s68, 32768
    buffer_load_dwordx4 v126, s[44:47], s68 offen lds
    s_add_u32 m0, s69, 8192
    s_add_u32 s68, s33, 0
    s_and_b32 s68, s68, 7
    s_mul_i32 s68, s68, 43
    s_add_u32 s68, s68, 19
    s_lshr_b32 s68, s68, 3
    s_lshl_b32 s68, s68, 15
    buffer_load_dwordx4 v126, s[44:47], s68 offen lds
    s_add_u32 m0, s69, 12288
    s_add_u32 s68, s68, 32768
    buffer_load_dwordx4 v126, s[44:47], s68 offen lds
    s_waitcnt vmcnt(8)
    s_barrier
    s_branch L_h_join
L_skip2:
    s_barrier
    buffer_store_dwordx4 v[40:43], v2, s[40:43], s55 offen offset:0 sc1
    buffer_store_dwordx4 v[44:47], v2, s[40:43], s55 offen offset:1024 sc1
    s_branch L_skip2d
L_spS0:
    s_mov_b32 s0, 0
L_splS0:
    ds_read_b32 v8, v127 offset:16
    s_add_u32 s0, s0, 1
    s_waitcnt lgkmcnt(0)
    v_cmp_gt_u32 vcc, 4, v8
    s_nop 1
    s_cbranch_vccz L_spdS0
    s_cmp_lt_u32 s0, 0x2000000
    s_cbranch_scc1 L_splS0
    s_branch L_spdS0
L_gpA1:
    s_mov_b32 s0, 0
L_gplA1:
    s_load_dwordx16 s[4:19], s[30:31], s70 glc
    s_waitcnt lgkmcnt(0)
    s_xor_b64 s[4:5], s[4:5], s[28:29]
    s_xor_b64 s[6:7], s[6:7], s[28:29]
    s_xor_b64 s[8:9], s[8:9], s[28:29]
    s_xor_b64 s[10:11], s[10:11], s[28:29]
    s_xor_b64 s[12:13], s[12:13], s[28:29]
    s_xor_b64 s[14:15], s[14:15], s[28:29]
    s_xor_b64 s[16:17], s[16:17], s[28:29]
    s_xor_b64 s[18:19], s[18:19], s[28:29]
    s_or_b64 s[4:5], s[4:5], s[6:7]
    s_or_b64 s[4:5], s[4:5], s[8:9]
    s_or_b64 s[4:5], s[4:5], s[10:11]
    s_or_b64 s[4:5], s[4:5], s[12:13]
    s_or_b64 s[4:5], s[4:5], s[14:15]
    s_or_b64 s[4:5], s[4:5], s[16:17]
    s_or_b64 s[4:5], s[4:5], s[18:19]
    s_cbranch_scc0 L_gpdA1
    s_add_u32 s0, s0, 1
    s_cmp_lt_u32 s0, 0x80000
    s_cbranch_scc1 L_gplA1
    s_branch L_gpdA1
L_spW2A:
    s_mov_b32 s0, 0
L_splW2A:
    ds_read_b32 v8, v127 offset:8
    s_add_u32 s0, s0, 1
    s_waitcnt lgkmcnt(0)
    v_cmp_gt_u32 vcc, 4, v8
    s_nop 1
    s_cbranch_vccz L_spdW2A
    s_cmp_lt_u32 s0, 0x2000000
    s_cbranch_scc1 L_splW2A
    s_branch L_spdW2A
L_spW3:
    s_mov_b32 s0, 0
L_splW3:
    ds_read_b32 v8, v127 offset:12
    s_add_u32 s0, s0, 1
    s_waitcnt lgkmcnt(0)
    v_cmp_gt_u32 vcc, 4, v8
    s_nop 1
    s_cbranch_vccz L_spdW3
    s_cmp_lt_u32 s0, 0x2000000
    s_cbranch_scc1 L_splW3
    s_branch L_spdW3
L_bumpR:
    s_mov_b64 exec, 1
    buffer_store_dword v6, off, s[40:43], s27 sc1
    s_mov_b64 exec, -1
    s_branch L_bumpRd
L_gpT:
    s_mov_b32 s0, 0
L_gplT:
    s_load_dwordx8 s[4:11], s[30:31], s26 glc
    s_waitcnt lgkmcnt(0)
    s_xor_b64 s[4:5], s[4:5], s[28:29]
    s_xor_b64 s[6:7], s[6:7], s[28:29]
    s_xor_b64 s[8:9], s[8:9], s[28:29]
    s_xor_b64 s[10:11], s[10:11], s[28:29]
    s_or_b64 s[4:5], s[4:5], s[6:7]
    s_or_b64 s[4:5], s[4:5], s[8:9]
    s_or_b64 s[4:5], s[4:5], s[10:11]
    s_cbranch_scc0 L_gpdT
    s_add_u32 s0, s0, 1
    s_cmp_lt_u32 s0, 0x80000
    s_cbranch_scc1 L_gplT
    s_branch L_gpdT
L_spR1:
    s_mov_b32 s0, 0
L_splR1:
    ds_read_b32 v18, v127 offset:0
    s_add_u32 s0, s0, 1
    s_waitcnt lgkmcnt(0)
    v_cmp_gt_u32 vcc, 4, v18
    s_nop 1
    s_cbranch_vccz L_spdR1
    s_cmp_lt_u32 s0, 0x2000000
    s_cbranch_scc1 L_splR1
    s_branch L_spdR1
L_spR2:
    s_mov_b32 s0, 0
L_splR2:
    ds_read_b32 v18, v127 offset:4
    s_add_u32 s0, s0, 1
    s_waitcnt lgkmcnt(0)
    v_cmp_gt_u32 vcc, 4, v18
    s_nop 1
    s_cbranch_vccz L_spdR2
    s_cmp_lt_u32 s0, 0x2000000
    s_cbranch_scc1 L_splR2
    s_branch L_spdR2
L_bumpC:
    s_mov_b64 exec, 1
    buffer_store_dword v249, off, s[40:43], s27 sc1
    s_mov_b64 exec, -1
    s_branch L_bumpCd
L_gpZ0:
    s_mov_b32 s0, 0
L_gplZ0:
    s_load_dwordx8 s[4:11], s[30:31], s70 glc
    s_waitcnt lgkmcnt(0)
    s_xor_b64 s[4:5], s[4:5], s[28:29]
    s_xor_b64 s[6:7], s[6:7], s[28:29]
    s_xor_b64 s[8:9], s[8:9], s[28:29]
    s_xor_b64 s[10:11], s[10:11], s[28:29]
    s_or_b64 s[4:5], s[4:5], s[6:7]
    s_or_b64 s[4:5], s[4:5], s[8:9]
    s_or_b64 s[4:5], s[4:5], s[10:11]
    s_cbranch_scc0 L_gpdZ0
    s_add_u32 s0, s0, 1
    s_cmp_lt_u32 s0, 0x80000
    s_cbranch_scc1 L_gplZ0
    s_branch L_gpdZ0
L_spZ:
    s_mov_b32 s0, 0
L_splZ:
    ds_read_b32 v18, v127 offset:20
    s_add_u32 s0, s0, 1
    s_waitcnt lgkmcnt(0)
    v_cmp_gt_u32 vcc, 4, v18
    s_nop 1
    s_cbranch_vccz L_spdZ
    s_cmp_lt_u32 s0, 0x2000000
    s_cbranch_scc1 L_splZ
    s_branch L_spdZ
L_end:
    s_endpgm

.section .rodata,"a"
.p2align 6
.amdhsa_kernel parallel_sum__ssm_conv_h3__mixer_channel_mlp__prompt_kernel
  .amdhsa_next_free_vgpr 256
  .amdhsa_next_free_sgpr 102
  .amdhsa_accum_offset 256
  .amdhsa_group_segment_fixed_size 0
  .amdhsa_kernarg_size 112
  .amdhsa_user_sgpr_count 2
  .amdhsa_user_sgpr_kernarg_segment_ptr 1
  .amdhsa_system_sgpr_workgroup_id_x 1
.end_amdhsa_kernel
```
